```python
import torch

def _softmax(x, axis=-1):
    return torch.softmax(x, dim=axis)
def _gelu(x):
    return torch.nn.functional.gelu(x, approximate="tanh")
def _silu(x):
    return torch.nn.functional.silu(x)
def _sigmoid(x):
    return torch.sigmoid(x)
def _layernorm(x, axis=-1, eps=1e-5):
    m = x.mean(dim=axis, keepdim=True)
    v = x.var(dim=axis, keepdim=True, unbiased=False)
    return (x - m) / torch.sqrt(v + eps)
def _scatter_add(tgt, idx, src, axis=0):
    return tgt.clone().index_add_(axis, idx, src)
def _segment_sum(src, seg, n):
    out = torch.zeros((n,) + src.shape[1:], dtype=src.dtype)
    return out.index_add_(0, seg, src)
def _pad(x, pw):
    flat = tuple(v for pair in reversed(pw) for v in pair)
    return torch.nn.functional.pad(x, flat)

kernel_name = 'recurrent_scan__mha_block_cached__glu_gated_swiglu__decode'

def setup_inputs():

    _w = (lambda a: (lambda t: t.to(torch.bfloat16) if t.is_floating_point() else t)(torch.as_tensor(a)))
    def _A_setup():
        B, Sq, D = 8, 1, 576
        H, Sk, Dh = 32, 4096, 128
        return {
            "x": _w((lambda *s: torch.randn(*s, dtype=torch.bfloat16) * 0.05)(B, Sq, D)),
            "k_cache": _w((lambda *s: torch.randn(*s, dtype=torch.bfloat16) * 3.2)(B, H, Sk, Dh)),
            "v_cache": _w((lambda *s: torch.randn(*s, dtype=torch.bfloat16) * 3.2)(B, H, Sk, Dh)),
            "wq": _w((lambda *s: torch.randn(*s, dtype=torch.bfloat16) * 3.2)(D, H * Dh) * (D ** -0.5)),
            "wo": _w((lambda *s: torch.randn(*s, dtype=torch.bfloat16) * 3.2)(H * Dh, D) * ((H * Dh) ** -0.5)),
        }
    _A_in = _A_setup()

    def _B_setup():
        B, S, D, F = 8, 1, 576, 4608
        return {
            "x": _w((lambda *s: torch.randn(*s, dtype=torch.bfloat16) * 0.05)(B, S, D)),
            "w1": _w((lambda *s: torch.randn(*s, dtype=torch.bfloat16) * 0.4)(D, F) * (2.0 / D) ** 0.5),
            "w3": _w((lambda *s: torch.randn(*s, dtype=torch.bfloat16) * 0.4)(D, F) * (2.0 / D) ** 0.5),
            "w2": _w((lambda *s: torch.randn(*s, dtype=torch.bfloat16) * 0.4)(F, D) * (2.0 / F) ** 0.5),
        }
    _B_in = _B_setup()

    return {
        "A_x": _A_in["x"],
        "A_k_cache": _A_in["k_cache"],
        "A_v_cache": _A_in["v_cache"],
        "A_wq": _A_in["wq"],
        "A_wo": _A_in["wo"],
        "B_x": _B_in["x"],
        "B_w1": _B_in["w1"],
        "B_w3": _B_in["w3"],
        "B_w2": _B_in["w2"],
    }

def reference(A_x, A_k_cache, A_v_cache, A_wq, A_wo, B_x, B_w1, B_w3, B_w2):
    def _A_ref(x, k_cache, v_cache, wq, wo):
        B, Sq, D = x.shape
        H, Dh = 32, 128
        q = (lambda x, *d: x.permute(*d))((x @ wq).reshape(B, Sq, H, Dh), 0, 2, 1, 3)
        scores = torch.einsum("bhqd,bhkd->bhqk", q, k_cache) * (Dh ** -0.5)
        p = _softmax(scores, axis=-1)
        o = torch.einsum("bhqk,bhkd->bhqd", p, v_cache)
        return (lambda x, *d: x.permute(*d))(o, 0, 2, 1, 3).reshape(B, Sq, H * Dh) @ wo

    def _B_ref(x, w1, w3, w2):
        gate = torch.einsum("bsd,df->bsf", x, w1)
        up = torch.einsum("bsd,df->bsf", x, w3)
        h = _silu(gate) * up
        out = torch.einsum("bsf,fd->bsd", h, w2)
        return out

    x = A_x
    xn = _layernorm(x, axis=-1)
    s = _A_ref(xn, A_k_cache, A_v_cache, A_wq, A_wo)
    g = _silu(_B_ref(xn, B_w1, B_w3, B_w2))
    return x + s * g
```

```asm
; @launch grid=(256,1,1) block=(768,1,1) lds=45696
.amdgcn_target "amdgcn-amd-amdhsa--gfx950"
.text
.globl recurrent_scan__mha_block_cached__glu_gated_swiglu__decode_kernel
.p2align 8
.type recurrent_scan__mha_block_cached__glu_gated_swiglu__decode_kernel,@function
recurrent_scan__mha_block_cached__glu_gated_swiglu__decode_kernel:
    s_cmp_ge_u32 s2, 256
    s_cbranch_scc1 L_end
    s_load_dwordx16 s[4:19], s[0:1], 0
    s_load_dwordx8 s[20:27], s[0:1], 64
    s_memrealtime s[62:63]
    v_lshrrev_b32 v2, 6, v0
    v_and_b32 v1, 63, v0
    v_readfirstlane_b32 s3, v2
    v_lshlrev_b32 v2, 4, v1
    s_and_b32 s69, s2, 7
    s_lshr_b32 s70, s2, 3
    s_and_b32 s29, s70, 3
    s_lshl2_add_u32 s29, s69, s29
    s_lshr_b32 s28, s70, 2
    s_lshl_b32 s65, s28, 5
    s_add_u32 s65, s65, s29
    s_lshl_b32 s30, s65, 20
    s_lshl_b32 s54, s3, 12
    s_lshr_b32 s31, s65, 0
    s_and_b32 s31, s31, 1
    s_lshl_b32 s31, s31, 17
    s_add_u32 s54, s54, s31
    s_mul_i32 s31, s65, 1048576
    s_add_u32 s54, s54, s31
    s_and_b32 s54, s54, 0xfffff
    s_mul_i32 s31, s28, 1152
    s_lshl_b32 s32, s29, 8
    s_min_u32 s67, s3, 8
    s_cmp_ge_u32 s3, 8
    s_cbranch_scc1 L_w
    s_waitcnt lgkmcnt(0)
    s_add_u32 s36, s6, s30
    s_addc_u32 s37, s7, 0
    s_mov_b32 s38, 0x100000
    s_mov_b32 s39, 0x20000
    s_setprio 3
    buffer_load_dwordx4 v[16:19], v2, s[36:39], s54 offen offset:0 nt
    buffer_load_dwordx4 v[60:63], v2, s[36:39], s54 offen offset:1024 nt
    buffer_load_dwordx4 v[64:67], v2, s[36:39], s54 offen offset:2048 nt
    buffer_load_dwordx4 v[68:71], v2, s[36:39], s54 offen offset:3072 nt
    s_add_u32 s54, s54, 0x8000
    s_and_b32 s54, s54, 0xfffff
    s_barrier
    s_mov_b32 s48, s26
    s_mov_b32 s49, s27
    s_mov_b32 s50, 0x800000
    s_mov_b32 s51, 0x20000
    s_mov_b32 s17, s62
    s_cmp_eq_u32 s2, 33
    s_cselect_b32 s15, 1, 0
    s_mov_b32 s18, 0
    s_add_u32 s40, s4, s31
    s_addc_u32 s41, s5, 0
    s_mov_b32 s42, 0x488
    s_mov_b32 s43, 0x20000
    s_add_u32 s52, s8, s30
    s_addc_u32 s53, s9, 0
    s_mov_b32 s56, 0xaaaaaaaa
    s_mov_b32 s57, 0xaaaaaaaa
    s_mov_b32 s58, 0xcccccccc
    s_mov_b32 s59, 0xcccccccc
    v_and_b32 v0, 15, v1
    v_lshlrev_b32 v0, 4, v0
    s_waitcnt vmcnt(3)
    buffer_load_dwordx4 v[72:75], v2, s[36:39], s54 offen offset:0 nt
    s_waitcnt vmcnt(3)
    buffer_load_dwordx4 v[76:79], v2, s[36:39], s54 offen offset:1024 nt
    s_waitcnt vmcnt(3)
    buffer_load_dwordx4 v[80:83], v2, s[36:39], s54 offen offset:2048 nt
    s_waitcnt vmcnt(3)
    buffer_load_dwordx4 v[84:87], v2, s[36:39], s54 offen offset:3072 nt
    s_add_u32 s54, s54, 0x8000
    s_and_b32 s54, s54, 0xfffff
    s_waitcnt vmcnt(3)
    buffer_load_dwordx4 v[88:91], v2, s[36:39], s54 offen offset:0 nt
    s_waitcnt vmcnt(3)
    buffer_load_dwordx4 v[92:95], v2, s[36:39], s54 offen offset:1024 nt
    s_waitcnt vmcnt(3)
    buffer_load_dwordx4 v[96:99], v2, s[36:39], s54 offen offset:2048 nt
    s_waitcnt vmcnt(3)
    buffer_load_dwordx4 v[100:103], v2, s[36:39], s54 offen offset:3072 nt
    s_add_u32 s54, s54, 0x8000
    s_and_b32 s54, s54, 0xfffff
    s_waitcnt vmcnt(3)
    buffer_load_dwordx4 v[40:43], v2, s[36:39], s54 offen offset:0 nt
    s_waitcnt vmcnt(3)
    buffer_load_dwordx4 v[44:47], v2, s[36:39], s54 offen offset:1024 nt
    s_waitcnt vmcnt(3)
    buffer_load_dwordx4 v[48:51], v2, s[36:39], s54 offen offset:2048 nt
    s_waitcnt vmcnt(3)
    buffer_load_dwordx4 v[52:55], v2, s[36:39], s54 offen offset:3072 nt
    s_add_u32 s54, s54, 0x8000
    s_and_b32 s54, s54, 0xfffff
    s_waitcnt vmcnt(3)
    buffer_load_dwordx4 v[56:59], v2, s[36:39], s54 offen offset:0 nt
    s_waitcnt vmcnt(3)
    buffer_load_dwordx4 v[104:107], v2, s[36:39], s54 offen offset:1024 nt
    s_waitcnt vmcnt(3)
    buffer_load_dwordx4 v[108:111], v2, s[36:39], s54 offen offset:2048 nt
    s_waitcnt vmcnt(3)
    buffer_load_dwordx4 v[112:115], v2, s[36:39], s54 offen offset:3072 nt
    s_add_u32 s54, s54, 0x8000
    s_and_b32 s54, s54, 0xfffff
    s_waitcnt vmcnt(3)
    buffer_load_dwordx4 v[116:119], v2, s[36:39], s54 offen offset:0 nt
    s_waitcnt vmcnt(3)
    buffer_load_dwordx4 v[120:123], v2, s[36:39], s54 offen offset:1024 nt
    s_waitcnt vmcnt(3)
    buffer_load_dwordx4 v[124:127], v2, s[36:39], s54 offen offset:2048 nt
    s_waitcnt vmcnt(3)
    buffer_load_dwordx4 v[128:131], v2, s[36:39], s54 offen offset:3072 nt
    s_add_u32 s54, s54, 0x8000
    s_and_b32 s54, s54, 0xfffff
    s_waitcnt vmcnt(3)
    buffer_load_dwordx4 v[132:135], v2, s[36:39], s54 offen offset:0 nt
    s_waitcnt vmcnt(3)
    buffer_load_dwordx4 v[136:139], v2, s[36:39], s54 offen offset:1024 nt
    s_waitcnt vmcnt(3)
    buffer_load_dwordx4 v[140:143], v2, s[36:39], s54 offen offset:2048 nt
    s_waitcnt vmcnt(3)
    buffer_load_dwordx4 v[144:147], v2, s[36:39], s54 offen offset:3072 nt
    s_add_u32 s54, s54, 0x8000
    s_and_b32 s54, s54, 0xfffff
    s_waitcnt vmcnt(3)
    buffer_load_dwordx4 v[148:151], v2, s[36:39], s54 offen offset:0 nt
    s_waitcnt vmcnt(3)
    buffer_load_dwordx4 v[152:155], v2, s[36:39], s54 offen offset:1024 nt
    s_waitcnt vmcnt(3)
    buffer_load_dwordx4 v[156:159], v2, s[36:39], s54 offen offset:2048 nt
    s_waitcnt vmcnt(3)
    buffer_load_dwordx4 v[160:163], v2, s[36:39], s54 offen offset:3072 nt
    s_add_u32 s54, s54, 0x8000
    s_and_b32 s54, s54, 0xfffff
    s_waitcnt vmcnt(3)
    buffer_load_dwordx4 v[164:167], v2, s[36:39], s54 offen offset:0 nt
    s_waitcnt vmcnt(3)
    buffer_load_dwordx4 v[12:15], v2, s[36:39], s54 offen offset:1024 nt
    s_waitcnt vmcnt(3)
    buffer_load_dwordx4 v[20:23], v2, s[36:39], s54 offen offset:2048 nt
    s_waitcnt vmcnt(3)
    buffer_load_dwordx4 v[4:7], v2, s[36:39], s54 offen offset:3072 nt
    s_add_u32 s54, s54, 0x8000
    s_and_b32 s54, s54, 0xfffff
    s_waitcnt vmcnt(3)
    buffer_load_dwordx4 v[36:39], v2, s[36:39], s54 offen offset:0 nt
    v_mov_b32 v24, 0
L_lwq:
    ds_read_b32 v25, v24 offset:6228
    s_waitcnt lgkmcnt(0)
    v_readfirstlane_b32 s33, v25
    s_nop 0
    s_cmp_ge_u32 s33, 1
    s_cbranch_scc1 L_lgq
    s_sleep 1
    s_branch L_lwq
L_lgq:
    ds_read_b128 v[8:11], v0 offset:45440
    s_waitcnt lgkmcnt(0)
    v_dot2_f32_bf16 v24, v16, v8, 0
    v_dot2_f32_bf16 v24, v17, v9, v24
    v_dot2_f32_bf16 v24, v18, v10, v24
    v_dot2_f32_bf16 v24, v19, v11, v24
    v_dot2_f32_bf16 v25, v60, v8, 0
    v_dot2_f32_bf16 v25, v61, v9, v25
    v_dot2_f32_bf16 v25, v62, v10, v25
    v_dot2_f32_bf16 v25, v63, v11, v25
    v_add_f32_dpp v26, v24, v24 row_ror:8 row_mask:0xf bank_mask:0x3
    s_nop 1
    v_add_f32_dpp v26, v25, v25 row_ror:8 row_mask:0xf bank_mask:0xc
    buffer_load_dwordx4 v[60:63], v2, s[36:39], s54 offen offset:1024 nt
    v_dot2_f32_bf16 v24, v64, v8, 0
    v_dot2_f32_bf16 v24, v65, v9, v24
    v_dot2_f32_bf16 v24, v66, v10, v24
    v_dot2_f32_bf16 v24, v67, v11, v24
    buffer_load_dwordx4 v[64:67], v2, s[36:39], s54 offen offset:2048 nt
    v_dot2_f32_bf16 v25, v68, v8, 0
    v_dot2_f32_bf16 v25, v69, v9, v25
    v_dot2_f32_bf16 v25, v70, v10, v25
    v_dot2_f32_bf16 v25, v71, v11, v25
    v_add_f32_dpp v27, v24, v24 row_ror:8 row_mask:0xf bank_mask:0x3
    s_nop 1
    v_add_f32_dpp v27, v25, v25 row_ror:8 row_mask:0xf bank_mask:0xc
    v_add_f32_dpp v28, v26, v26 row_shl:4 row_mask:0xf bank_mask:0x5
    s_nop 1
    v_add_f32_dpp v28, v27, v27 row_shr:4 row_mask:0xf bank_mask:0xa
    buffer_load_dwordx4 v[68:71], v2, s[36:39], s54 offen offset:3072 nt
    s_add_u32 s54, s54, 0x8000
    s_and_b32 s54, s54, 0xfffff
    v_dot2_f32_bf16 v24, v72, v8, 0
    v_dot2_f32_bf16 v24, v73, v9, v24
    v_dot2_f32_bf16 v24, v74, v10, v24
    v_dot2_f32_bf16 v24, v75, v11, v24
    v_dot2_f32_bf16 v25, v76, v8, 0
    v_dot2_f32_bf16 v25, v77, v9, v25
    v_dot2_f32_bf16 v25, v78, v10, v25
    v_dot2_f32_bf16 v25, v79, v11, v25
    v_add_f32_dpp v26, v24, v24 row_ror:8 row_mask:0xf bank_mask:0x3
    s_nop 1
    v_add_f32_dpp v26, v25, v25 row_ror:8 row_mask:0xf bank_mask:0xc
    v_dot2_f32_bf16 v24, v80, v8, 0
    v_dot2_f32_bf16 v24, v81, v9, v24
    v_dot2_f32_bf16 v24, v82, v10, v24
    v_dot2_f32_bf16 v24, v83, v11, v24
    v_dot2_f32_bf16 v25, v84, v8, 0
    v_dot2_f32_bf16 v25, v85, v9, v25
    v_dot2_f32_bf16 v25, v86, v10, v25
    v_dot2_f32_bf16 v25, v87, v11, v25
    v_add_f32_dpp v27, v24, v24 row_ror:8 row_mask:0xf bank_mask:0x3
    s_nop 1
    v_add_f32_dpp v27, v25, v25 row_ror:8 row_mask:0xf bank_mask:0xc
    v_add_f32_dpp v29, v26, v26 row_shl:4 row_mask:0xf bank_mask:0x5
    s_nop 1
    v_add_f32_dpp v29, v27, v27 row_shr:4 row_mask:0xf bank_mask:0xa
    v_cndmask_b32 v32, v28, v29, s[58:59]
    v_cndmask_b32 v33, v29, v28, s[58:59]
    s_nop 1
    v_add_f32_dpp v30, v33, v32 quad_perm:[2,3,0,1] row_mask:0xf bank_mask:0xf
    v_dot2_f32_bf16 v24, v88, v8, 0
    v_dot2_f32_bf16 v24, v89, v9, v24
    v_dot2_f32_bf16 v24, v90, v10, v24
    v_dot2_f32_bf16 v24, v91, v11, v24
    buffer_load_dwordx4 v[72:75], v2, s[36:39], s54 offen offset:0 nt
    v_dot2_f32_bf16 v25, v92, v8, 0
    v_dot2_f32_bf16 v25, v93, v9, v25
    v_dot2_f32_bf16 v25, v94, v10, v25
    v_dot2_f32_bf16 v25, v95, v11, v25
    v_add_f32_dpp v26, v24, v24 row_ror:8 row_mask:0xf bank_mask:0x3
    s_nop 1
    v_add_f32_dpp v26, v25, v25 row_ror:8 row_mask:0xf bank_mask:0xc
    v_dot2_f32_bf16 v24, v96, v8, 0
    v_dot2_f32_bf16 v24, v97, v9, v24
    v_dot2_f32_bf16 v24, v98, v10, v24
    v_dot2_f32_bf16 v24, v99, v11, v24
    v_dot2_f32_bf16 v25, v100, v8, 0
    v_dot2_f32_bf16 v25, v101, v9, v25
    v_dot2_f32_bf16 v25, v102, v10, v25
    v_dot2_f32_bf16 v25, v103, v11, v25
    v_add_f32_dpp v27, v24, v24 row_ror:8 row_mask:0xf bank_mask:0x3
    s_nop 1
    v_add_f32_dpp v27, v25, v25 row_ror:8 row_mask:0xf bank_mask:0xc
    v_add_f32_dpp v28, v26, v26 row_shl:4 row_mask:0xf bank_mask:0x5
    s_nop 1
    v_add_f32_dpp v28, v27, v27 row_shr:4 row_mask:0xf bank_mask:0xa
    v_dot2_f32_bf16 v24, v40, v8, 0
    v_dot2_f32_bf16 v24, v41, v9, v24
    v_dot2_f32_bf16 v24, v42, v10, v24
    v_dot2_f32_bf16 v24, v43, v11, v24
    v_dot2_f32_bf16 v25, v44, v8, 0
    v_dot2_f32_bf16 v25, v45, v9, v25
    v_dot2_f32_bf16 v25, v46, v10, v25
    v_dot2_f32_bf16 v25, v47, v11, v25
    v_add_f32_dpp v26, v24, v24 row_ror:8 row_mask:0xf bank_mask:0x3
    s_nop 1
    v_add_f32_dpp v26, v25, v25 row_ror:8 row_mask:0xf bank_mask:0xc
    v_dot2_f32_bf16 v24, v48, v8, 0
    v_dot2_f32_bf16 v24, v49, v9, v24
    v_dot2_f32_bf16 v24, v50, v10, v24
    v_dot2_f32_bf16 v24, v51, v11, v24
    buffer_load_dwordx4 v[76:79], v2, s[36:39], s54 offen offset:1024 nt
    v_dot2_f32_bf16 v25, v52, v8, 0
    v_dot2_f32_bf16 v25, v53, v9, v25
    v_dot2_f32_bf16 v25, v54, v10, v25
    v_dot2_f32_bf16 v25, v55, v11, v25
    v_add_f32_dpp v27, v24, v24 row_ror:8 row_mask:0xf bank_mask:0x3
    s_nop 1
    v_add_f32_dpp v27, v25, v25 row_ror:8 row_mask:0xf bank_mask:0xc
    v_add_f32_dpp v29, v26, v26 row_shl:4 row_mask:0xf bank_mask:0x5
    s_nop 1
    v_add_f32_dpp v29, v27, v27 row_shr:4 row_mask:0xf bank_mask:0xa
    v_cndmask_b32 v32, v28, v29, s[58:59]
    v_cndmask_b32 v33, v29, v28, s[58:59]
    s_nop 1
    v_add_f32_dpp v31, v33, v32 quad_perm:[2,3,0,1] row_mask:0xf bank_mask:0xf
    v_cndmask_b32 v32, v30, v31, s[56:57]
    v_cndmask_b32 v33, v31, v30, s[56:57]
    s_nop 1
    v_add_f32_dpp v32, v33, v32 quad_perm:[1,0,3,2] row_mask:0xf bank_mask:0xf
    v_cvt_pk_bf16_f32 v32, v32, v32
    v_and_b32 v32, 0xffff0000, v32
    v_mul_f32 v32, 0x3db504f3, v32
    v_cvt_pk_bf16_f32 v16, v32, v32
    v_and_b32 v16, 0xffff0000, v16
    v_dot2_f32_bf16 v24, v56, v8, 0
    v_dot2_f32_bf16 v24, v57, v9, v24
    v_dot2_f32_bf16 v24, v58, v10, v24
    v_dot2_f32_bf16 v24, v59, v11, v24
    v_dot2_f32_bf16 v25, v104, v8, 0
    v_dot2_f32_bf16 v25, v105, v9, v25
    v_dot2_f32_bf16 v25, v106, v10, v25
    v_dot2_f32_bf16 v25, v107, v11, v25
    v_add_f32_dpp v26, v24, v24 row_ror:8 row_mask:0xf bank_mask:0x3
    s_nop 1
    v_add_f32_dpp v26, v25, v25 row_ror:8 row_mask:0xf bank_mask:0xc
    v_dot2_f32_bf16 v24, v108, v8, 0
    v_dot2_f32_bf16 v24, v109, v9, v24
    v_dot2_f32_bf16 v24, v110, v10, v24
    v_dot2_f32_bf16 v24, v111, v11, v24
    v_dot2_f32_bf16 v25, v112, v8, 0
    v_dot2_f32_bf16 v25, v113, v9, v25
    v_dot2_f32_bf16 v25, v114, v10, v25
    v_dot2_f32_bf16 v25, v115, v11, v25
    v_add_f32_dpp v27, v24, v24 row_ror:8 row_mask:0xf bank_mask:0x3
    s_nop 1
    v_add_f32_dpp v27, v25, v25 row_ror:8 row_mask:0xf bank_mask:0xc
    v_add_f32_dpp v28, v26, v26 row_shl:4 row_mask:0xf bank_mask:0x5
    s_nop 1
    v_add_f32_dpp v28, v27, v27 row_shr:4 row_mask:0xf bank_mask:0xa
    v_dot2_f32_bf16 v24, v116, v8, 0
    v_dot2_f32_bf16 v24, v117, v9, v24
    v_dot2_f32_bf16 v24, v118, v10, v24
    v_dot2_f32_bf16 v24, v119, v11, v24
    buffer_load_dwordx4 v[80:83], v2, s[36:39], s54 offen offset:2048 nt
    v_dot2_f32_bf16 v25, v120, v8, 0
    v_dot2_f32_bf16 v25, v121, v9, v25
    v_dot2_f32_bf16 v25, v122, v10, v25
    v_dot2_f32_bf16 v25, v123, v11, v25
    v_add_f32_dpp v26, v24, v24 row_ror:8 row_mask:0xf bank_mask:0x3
    s_nop 1
    v_add_f32_dpp v26, v25, v25 row_ror:8 row_mask:0xf bank_mask:0xc
    v_dot2_f32_bf16 v24, v124, v8, 0
    v_dot2_f32_bf16 v24, v125, v9, v24
    v_dot2_f32_bf16 v24, v126, v10, v24
    v_dot2_f32_bf16 v24, v127, v11, v24
    v_dot2_f32_bf16 v25, v128, v8, 0
    v_dot2_f32_bf16 v25, v129, v9, v25
    v_dot2_f32_bf16 v25, v130, v10, v25
    v_dot2_f32_bf16 v25, v131, v11, v25
    v_add_f32_dpp v27, v24, v24 row_ror:8 row_mask:0xf bank_mask:0x3
    s_nop 1
    v_add_f32_dpp v27, v25, v25 row_ror:8 row_mask:0xf bank_mask:0xc
    v_add_f32_dpp v29, v26, v26 row_shl:4 row_mask:0xf bank_mask:0x5
    s_nop 1
    v_add_f32_dpp v29, v27, v27 row_shr:4 row_mask:0xf bank_mask:0xa
    v_cndmask_b32 v32, v28, v29, s[58:59]
    v_cndmask_b32 v33, v29, v28, s[58:59]
    s_nop 1
    v_add_f32_dpp v30, v33, v32 quad_perm:[2,3,0,1] row_mask:0xf bank_mask:0xf
    v_dot2_f32_bf16 v24, v132, v8, 0
    v_dot2_f32_bf16 v24, v133, v9, v24
    v_dot2_f32_bf16 v24, v134, v10, v24
    v_dot2_f32_bf16 v24, v135, v11, v24
    v_dot2_f32_bf16 v25, v136, v8, 0
    v_dot2_f32_bf16 v25, v137, v9, v25
    v_dot2_f32_bf16 v25, v138, v10, v25
    v_dot2_f32_bf16 v25, v139, v11, v25
    v_add_f32_dpp v26, v24, v24 row_ror:8 row_mask:0xf bank_mask:0x3
    s_nop 1
    v_add_f32_dpp v26, v25, v25 row_ror:8 row_mask:0xf bank_mask:0xc
    v_dot2_f32_bf16 v24, v140, v8, 0
    v_dot2_f32_bf16 v24, v141, v9, v24
    v_dot2_f32_bf16 v24, v142, v10, v24
    v_dot2_f32_bf16 v24, v143, v11, v24
    buffer_load_dwordx4 v[84:87], v2, s[36:39], s54 offen offset:3072 nt
    s_add_u32 s54, s54, 0x8000
    s_and_b32 s54, s54, 0xfffff
    v_dot2_f32_bf16 v25, v144, v8, 0
    v_dot2_f32_bf16 v25, v145, v9, v25
    v_dot2_f32_bf16 v25, v146, v10, v25
    v_dot2_f32_bf16 v25, v147, v11, v25
    v_add_f32_dpp v27, v24, v24 row_ror:8 row_mask:0xf bank_mask:0x3
    s_nop 1
    v_add_f32_dpp v27, v25, v25 row_ror:8 row_mask:0xf bank_mask:0xc
    v_add_f32_dpp v28, v26, v26 row_shl:4 row_mask:0xf bank_mask:0x5
    s_nop 1
    v_add_f32_dpp v28, v27, v27 row_shr:4 row_mask:0xf bank_mask:0xa
    v_dot2_f32_bf16 v24, v148, v8, 0
    v_dot2_f32_bf16 v24, v149, v9, v24
    v_dot2_f32_bf16 v24, v150, v10, v24
    v_dot2_f32_bf16 v24, v151, v11, v24
    v_dot2_f32_bf16 v25, v152, v8, 0
    v_dot2_f32_bf16 v25, v153, v9, v25
    v_dot2_f32_bf16 v25, v154, v10, v25
    v_dot2_f32_bf16 v25, v155, v11, v25
    v_add_f32_dpp v26, v24, v24 row_ror:8 row_mask:0xf bank_mask:0x3
    s_nop 1
    v_add_f32_dpp v26, v25, v25 row_ror:8 row_mask:0xf bank_mask:0xc
    v_dot2_f32_bf16 v24, v156, v8, 0
    v_dot2_f32_bf16 v24, v157, v9, v24
    v_dot2_f32_bf16 v24, v158, v10, v24
    v_dot2_f32_bf16 v24, v159, v11, v24
    v_dot2_f32_bf16 v25, v160, v8, 0
    v_dot2_f32_bf16 v25, v161, v9, v25
    v_dot2_f32_bf16 v25, v162, v10, v25
    v_dot2_f32_bf16 v25, v163, v11, v25
    v_add_f32_dpp v27, v24, v24 row_ror:8 row_mask:0xf bank_mask:0x3
    s_nop 1
    v_add_f32_dpp v27, v25, v25 row_ror:8 row_mask:0xf bank_mask:0xc
    v_add_f32_dpp v29, v26, v26 row_shl:4 row_mask:0xf bank_mask:0x5
    s_nop 1
    v_add_f32_dpp v29, v27, v27 row_shr:4 row_mask:0xf bank_mask:0xa
    v_cndmask_b32 v32, v28, v29, s[58:59]
    v_cndmask_b32 v33, v29, v28, s[58:59]
    s_nop 1
    v_add_f32_dpp v31, v33, v32 quad_perm:[2,3,0,1] row_mask:0xf bank_mask:0xf
    v_cndmask_b32 v32, v30, v31, s[56:57]
    v_cndmask_b32 v33, v31, v30, s[56:57]
    s_nop 1
    v_add_f32_dpp v32, v33, v32 quad_perm:[1,0,3,2] row_mask:0xf bank_mask:0xf
    v_cvt_pk_bf16_f32 v32, v32, v32
    v_and_b32 v32, 0xffff0000, v32
    v_mul_f32 v32, 0x3db504f3, v32
    v_cvt_pk_bf16_f32 v17, v32, v32
    v_and_b32 v17, 0xffff0000, v17
    s_waitcnt vmcnt(11)
    v_dot2_f32_bf16 v24, v164, v8, 0
    v_dot2_f32_bf16 v24, v165, v9, v24
    v_dot2_f32_bf16 v24, v166, v10, v24
    v_dot2_f32_bf16 v24, v167, v11, v24
    buffer_load_dwordx4 v[88:91], v2, s[36:39], s54 offen offset:0 nt
    s_waitcnt vmcnt(11)
    v_dot2_f32_bf16 v25, v12, v8, 0
    v_dot2_f32_bf16 v25, v13, v9, v25
    v_dot2_f32_bf16 v25, v14, v10, v25
    v_dot2_f32_bf16 v25, v15, v11, v25
    v_add_f32_dpp v26, v24, v24 row_ror:8 row_mask:0xf bank_mask:0x3
    s_nop 1
    v_add_f32_dpp v26, v25, v25 row_ror:8 row_mask:0xf bank_mask:0xc
    s_waitcnt vmcnt(10)
    v_dot2_f32_bf16 v24, v20, v8, 0
    v_dot2_f32_bf16 v24, v21, v9, v24
    v_dot2_f32_bf16 v24, v22, v10, v24
    v_dot2_f32_bf16 v24, v23, v11, v24
    s_waitcnt vmcnt(9)
    v_dot2_f32_bf16 v25, v4, v8, 0
    v_dot2_f32_bf16 v25, v5, v9, v25
    v_dot2_f32_bf16 v25, v6, v10, v25
    v_dot2_f32_bf16 v25, v7, v11, v25
    v_add_f32_dpp v27, v24, v24 row_ror:8 row_mask:0xf bank_mask:0x3
    s_nop 1
    v_add_f32_dpp v27, v25, v25 row_ror:8 row_mask:0xf bank_mask:0xc
    v_add_f32_dpp v28, v26, v26 row_shl:4 row_mask:0xf bank_mask:0x5
    s_nop 1
    v_add_f32_dpp v28, v27, v27 row_shr:4 row_mask:0xf bank_mask:0xa
    s_waitcnt vmcnt(8)
    v_dot2_f32_bf16 v24, v36, v8, 0
    v_dot2_f32_bf16 v24, v37, v9, v24
    v_dot2_f32_bf16 v24, v38, v10, v24
    v_dot2_f32_bf16 v24, v39, v11, v24
    v_and_b32 v34, 1, v1
    v_lshlrev_b32 v34, 4, v34
    v_mov_b32 v35, 0xffff
    v_lshlrev_b32 v34, v34, v35
    v_bfe_u32 v35, v1, 1, 2
    v_cmp_eq_u32 vcc, 0, v35
    s_nop 1
    v_cndmask_b32 v4, 0, v34, vcc
    v_cmp_eq_u32 vcc, 1, v35
    s_nop 1
    v_cndmask_b32 v5, 0, v34, vcc
    v_cmp_eq_u32 vcc, 2, v35
    s_nop 1
    v_cndmask_b32 v6, 0, v34, vcc
    v_cmp_eq_u32 vcc, 3, v35
    s_nop 1
    v_cndmask_b32 v7, 0, v34, vcc
    v_and_b32 v36, 15, v1
    v_bfe_u32 v34, v1, 4, 1
    v_lshlrev_b32 v36, 5, v36
    v_lshl_add_u32 v36, v34, 4, v36
    s_lshl_b32 s33, s3, 9
    v_add_u32 v36, s33, v36
    s_mul_i32 s33, s29, 0x24000
    s_lshl_b32 s34, s67, 7
    s_add_u32 s33, s33, s34
    s_add_u32 s44, s12, s33
    s_addc_u32 s45, s13, 0
    s_sub_u32 s46, 0x480000, s33
    s_mov_b32 s47, 0x20000
    v_lshrrev_b32 v39, 3, v1
    v_and_b32 v34, 7, v1
    v_mul_u32_u24 v39, 0x2400, v39
    v_lshl_add_u32 v39, v34, 4, v39
    s_mov_b32 s55, 0
    v_lshrrev_b32 v34, 4, v1
    v_mul_u32_u24 v37, 528, v34
    s_mul_i32 s33, s3, 2112
    v_add_u32 v37, s33, v37
    v_bfrev_b32 v34, v1
    v_lshrrev_b32 v34, 26, v34
    v_and_b32 v34, 60, v34
    v_add_u32 v38, v37, v34
    s_mov_b32 s71, 0x200000
    s_mov_b64 vcc, 0
    s_mov_b32 s19, 1
    s_waitcnt vmcnt(2)
    buffer_load_dwordx4 v[92:95], v2, s[36:39], s54 offen offset:1024 nt
    v_dot2_f32_bf16 v25, v60, v8, 0
    v_dot2_f32_bf16 v25, v61, v9, v25
    v_dot2_f32_bf16 v25, v62, v10, v25
    v_dot2_f32_bf16 v25, v63, v11, v25
    v_add_f32_dpp v26, v24, v24 row_ror:8 row_mask:0xf bank_mask:0x3
    s_nop 1
    v_add_f32_dpp v26, v25, v25 row_ror:8 row_mask:0xf bank_mask:0xc
    s_waitcnt vmcnt(2)
    buffer_load_dwordx4 v[96:99], v2, s[36:39], s54 offen offset:2048 nt
    v_dot2_f32_bf16 v24, v64, v8, 0
    v_dot2_f32_bf16 v24, v65, v9, v24
    v_dot2_f32_bf16 v24, v66, v10, v24
    v_dot2_f32_bf16 v24, v67, v11, v24
    s_waitcnt vmcnt(2)
    buffer_load_dwordx4 v[100:103], v2, s[36:39], s54 offen offset:3072 nt
    s_add_u32 s54, s54, 0x8000
    s_and_b32 s54, s54, 0xfffff
    v_dot2_f32_bf16 v25, v68, v8, 0
    v_dot2_f32_bf16 v25, v69, v9, v25
    v_dot2_f32_bf16 v25, v70, v10, v25
    v_dot2_f32_bf16 v25, v71, v11, v25
    v_add_f32_dpp v27, v24, v24 row_ror:8 row_mask:0xf bank_mask:0x3
    s_nop 1
    v_add_f32_dpp v27, v25, v25 row_ror:8 row_mask:0xf bank_mask:0xc
    v_add_f32_dpp v29, v26, v26 row_shl:4 row_mask:0xf bank_mask:0x5
    s_nop 1
    v_add_f32_dpp v29, v27, v27 row_shr:4 row_mask:0xf bank_mask:0xa
    v_cndmask_b32 v32, v28, v29, s[58:59]
    v_cndmask_b32 v33, v29, v28, s[58:59]
    s_nop 1
    v_add_f32_dpp v30, v33, v32 quad_perm:[2,3,0,1] row_mask:0xf bank_mask:0xf
    s_waitcnt vmcnt(2)
    buffer_load_dwordx4 v[40:43], v2, s[36:39], s54 offen offset:0 nt
    v_dot2_f32_bf16 v24, v72, v8, 0
    v_dot2_f32_bf16 v24, v73, v9, v24
    v_dot2_f32_bf16 v24, v74, v10, v24
    v_dot2_f32_bf16 v24, v75, v11, v24
    s_waitcnt vmcnt(2)
    buffer_load_dwordx4 v[44:47], v2, s[36:39], s54 offen offset:1024 nt
    v_dot2_f32_bf16 v25, v76, v8, 0
    v_dot2_f32_bf16 v25, v77, v9, v25
    v_dot2_f32_bf16 v25, v78, v10, v25
    v_dot2_f32_bf16 v25, v79, v11, v25
    v_add_f32_dpp v26, v24, v24 row_ror:8 row_mask:0xf bank_mask:0x3
    s_nop 1
    v_add_f32_dpp v26, v25, v25 row_ror:8 row_mask:0xf bank_mask:0xc
    s_waitcnt vmcnt(2)
    buffer_load_dwordx4 v[48:51], v2, s[36:39], s54 offen offset:2048 nt
    v_dot2_f32_bf16 v24, v80, v8, 0
    v_dot2_f32_bf16 v24, v81, v9, v24
    v_dot2_f32_bf16 v24, v82, v10, v24
    v_dot2_f32_bf16 v24, v83, v11, v24
    s_waitcnt vmcnt(2)
    buffer_load_dwordx4 v[52:55], v2, s[36:39], s54 offen offset:3072 nt
    s_add_u32 s54, s54, 0x8000
    s_and_b32 s54, s54, 0xfffff
    v_dot2_f32_bf16 v25, v84, v8, 0
    v_dot2_f32_bf16 v25, v85, v9, v25
    v_dot2_f32_bf16 v25, v86, v10, v25
    v_dot2_f32_bf16 v25, v87, v11, v25
    v_add_f32_dpp v27, v24, v24 row_ror:8 row_mask:0xf bank_mask:0x3
    s_nop 1
    v_add_f32_dpp v27, v25, v25 row_ror:8 row_mask:0xf bank_mask:0xc
    v_add_f32_dpp v28, v26, v26 row_shl:4 row_mask:0xf bank_mask:0x5
    s_nop 1
    v_add_f32_dpp v28, v27, v27 row_shr:4 row_mask:0xf bank_mask:0xa
    s_waitcnt vmcnt(2)
    buffer_load_dwordx4 v[104:107], v39, s[44:47], s55 offen offset:0
    buffer_load_dwordx4 v[56:59], v2, s[36:39], s54 offen offset:0 nt
    v_dot2_f32_bf16 v24, v88, v8, 0
    v_dot2_f32_bf16 v24, v89, v9, v24
    v_dot2_f32_bf16 v24, v90, v10, v24
    v_dot2_f32_bf16 v24, v91, v11, v24
    s_waitcnt vmcnt(3)
    buffer_load_dwordx4 v[60:63], v2, s[36:39], s54 offen offset:1024 nt
    v_dot2_f32_bf16 v25, v92, v8, 0
    v_dot2_f32_bf16 v25, v93, v9, v25
    v_dot2_f32_bf16 v25, v94, v10, v25
    v_dot2_f32_bf16 v25, v95, v11, v25
    v_add_f32_dpp v26, v24, v24 row_ror:8 row_mask:0xf bank_mask:0x3
    s_nop 1
    v_add_f32_dpp v26, v25, v25 row_ror:8 row_mask:0xf bank_mask:0xc
    s_waitcnt vmcnt(3)
    buffer_load_dwordx4 v[64:67], v2, s[36:39], s54 offen offset:2048 nt
    v_dot2_f32_bf16 v24, v96, v8, 0
    v_dot2_f32_bf16 v24, v97, v9, v24
    v_dot2_f32_bf16 v24, v98, v10, v24
    v_dot2_f32_bf16 v24, v99, v11, v24
    s_memrealtime s[62:63]
    s_waitcnt vmcnt(2)
    buffer_load_dwordx4 v[68:71], v2, s[36:39], s54 offen offset:3072 nt
    s_add_u32 s54, s54, 0x8000
    s_and_b32 s54, s54, 0xfffff
    v_dot2_f32_bf16 v25, v100, v8, 0
    v_dot2_f32_bf16 v25, v101, v9, v25
    v_dot2_f32_bf16 v25, v102, v10, v25
    v_dot2_f32_bf16 v25, v103, v11, v25
    v_add_f32_dpp v27, v24, v24 row_ror:8 row_mask:0xf bank_mask:0x3
    s_nop 1
    v_add_f32_dpp v27, v25, v25 row_ror:8 row_mask:0xf bank_mask:0xc
    v_add_f32_dpp v29, v26, v26 row_shl:4 row_mask:0xf bank_mask:0x5
    s_nop 1
    v_add_f32_dpp v29, v27, v27 row_shr:4 row_mask:0xf bank_mask:0xa
    v_cndmask_b32 v32, v28, v29, s[58:59]
    v_cndmask_b32 v33, v29, v28, s[58:59]
    s_nop 1
    v_add_f32_dpp v31, v33, v32 quad_perm:[2,3,0,1] row_mask:0xf bank_mask:0xf
    v_cndmask_b32 v32, v30, v31, s[56:57]
    v_cndmask_b32 v33, v31, v30, s[56:57]
    s_nop 1
    v_add_f32_dpp v32, v33, v32 quad_perm:[1,0,3,2] row_mask:0xf bank_mask:0xf
    v_cvt_pk_bf16_f32 v32, v32, v32
    v_and_b32 v32, 0xffff0000, v32
    v_mul_f32 v32, 0x3db504f3, v32
    v_cvt_pk_bf16_f32 v18, v32, v32
    v_and_b32 v18, 0xffff0000, v18
    s_waitcnt lgkmcnt(0)
    s_mov_b32 s14, s62
    s_cmp_eq_u32 s15, 0
    s_cbranch_scc1 L_npk48
    s_cmp_lg_u32 s3, 0
    s_cbranch_scc1 L_npk48
    s_lshl2_add_u32 s33, s15, s71
    s_sub_u32 s33, s33, 4
    s_mov_b32 s34, s14
    s_atomic_swap s34, s[26:27], s33
L_npk48:
    s_add_u32 s71, s71, 256
    s_waitcnt vmcnt(2)
    buffer_load_dwordx4 v[72:75], v2, s[36:39], s54 offen offset:0 nt
    v_dot2_f32_bf16 v24, v40, v8, 0
    v_dot2_f32_bf16 v24, v41, v9, v24
    v_dot2_f32_bf16 v24, v42, v10, v24
    v_dot2_f32_bf16 v24, v43, v11, v24
    s_waitcnt vmcnt(2)
    buffer_load_dwordx4 v[108:111], v39, s[44:47], s55 offen offset:1152
    s_add_u32 s55, s55, 2304
    buffer_load_dwordx4 v[76:79], v2, s[36:39], s54 offen offset:1024 nt
    v_dot2_f32_bf16 v25, v44, v8, 0
    v_dot2_f32_bf16 v25, v45, v9, v25
    v_dot2_f32_bf16 v25, v46, v10, v25
    v_dot2_f32_bf16 v25, v47, v11, v25
    v_add_f32_dpp v26, v24, v24 row_ror:8 row_mask:0xf bank_mask:0x3
    s_nop 1
    v_add_f32_dpp v26, v25, v25 row_ror:8 row_mask:0xf bank_mask:0xc
    s_waitcnt vmcnt(3)
    buffer_load_dwordx4 v[80:83], v2, s[36:39], s54 offen offset:2048 nt
    v_dot2_f32_bf16 v24, v48, v8, 0
    v_dot2_f32_bf16 v24, v49, v9, v24
    v_dot2_f32_bf16 v24, v50, v10, v24
    v_dot2_f32_bf16 v24, v51, v11, v24
    s_waitcnt vmcnt(3)
    buffer_load_dwordx4 v[84:87], v2, s[36:39], s54 offen offset:3072 nt
    s_add_u32 s54, s54, 0x8000
    s_and_b32 s54, s54, 0xfffff
    v_dot2_f32_bf16 v25, v52, v8, 0
    v_dot2_f32_bf16 v25, v53, v9, v25
    v_dot2_f32_bf16 v25, v54, v10, v25
    v_dot2_f32_bf16 v25, v55, v11, v25
    v_add_f32_dpp v27, v24, v24 row_ror:8 row_mask:0xf bank_mask:0x3
    s_nop 1
    v_add_f32_dpp v27, v25, v25 row_ror:8 row_mask:0xf bank_mask:0xc
    v_add_f32_dpp v28, v26, v26 row_shl:4 row_mask:0xf bank_mask:0x5
    s_nop 1
    v_add_f32_dpp v28, v27, v27 row_shr:4 row_mask:0xf bank_mask:0xa
    s_waitcnt vmcnt(2)
    buffer_load_dwordx4 v[88:91], v2, s[36:39], s54 offen offset:0 nt
    v_dot2_f32_bf16 v24, v56, v8, 0
    v_dot2_f32_bf16 v24, v57, v9, v24
    v_dot2_f32_bf16 v24, v58, v10, v24
    v_dot2_f32_bf16 v24, v59, v11, v24
    s_waitcnt vmcnt(2)
    buffer_load_dwordx4 v[92:95], v2, s[36:39], s54 offen offset:1024 nt
    v_dot2_f32_bf16 v25, v60, v8, 0
    v_dot2_f32_bf16 v25, v61, v9, v25
    v_dot2_f32_bf16 v25, v62, v10, v25
    v_dot2_f32_bf16 v25, v63, v11, v25
    v_add_f32_dpp v26, v24, v24 row_ror:8 row_mask:0xf bank_mask:0x3
    s_nop 1
    v_add_f32_dpp v26, v25, v25 row_ror:8 row_mask:0xf bank_mask:0xc
    s_waitcnt vmcnt(2)
    buffer_load_dwordx4 v[112:115], v39, s[44:47], s55 offen offset:0
    buffer_load_dwordx4 v[96:99], v2, s[36:39], s54 offen offset:2048 nt
    v_dot2_f32_bf16 v24, v64, v8, 0
    v_dot2_f32_bf16 v24, v65, v9, v24
    v_dot2_f32_bf16 v24, v66, v10, v24
    v_dot2_f32_bf16 v24, v67, v11, v24
    s_memrealtime s[62:63]
    s_waitcnt vmcnt(3)
    buffer_load_dwordx4 v[100:103], v2, s[36:39], s54 offen offset:3072 nt
    s_add_u32 s54, s54, 0x8000
    s_and_b32 s54, s54, 0xfffff
    v_dot2_f32_bf16 v25, v68, v8, 0
    v_dot2_f32_bf16 v25, v69, v9, v25
    v_dot2_f32_bf16 v25, v70, v10, v25
    v_dot2_f32_bf16 v25, v71, v11, v25
    v_add_f32_dpp v27, v24, v24 row_ror:8 row_mask:0xf bank_mask:0x3
    s_nop 1
    v_add_f32_dpp v27, v25, v25 row_ror:8 row_mask:0xf bank_mask:0xc
    v_add_f32_dpp v29, v26, v26 row_shl:4 row_mask:0xf bank_mask:0x5
    s_nop 1
    v_add_f32_dpp v29, v27, v27 row_shr:4 row_mask:0xf bank_mask:0xa
    v_cndmask_b32 v32, v28, v29, s[58:59]
    v_cndmask_b32 v33, v29, v28, s[58:59]
    s_nop 1
    v_add_f32_dpp v30, v33, v32 quad_perm:[2,3,0,1] row_mask:0xf bank_mask:0xf
    s_waitcnt lgkmcnt(0)
    s_waitcnt vmcnt(3)
    buffer_load_dwordx4 v[40:43], v2, s[36:39], s54 offen offset:0 nt
    v_dot2_f32_bf16 v24, v72, v8, 0
    v_dot2_f32_bf16 v24, v73, v9, v24
    v_dot2_f32_bf16 v24, v74, v10, v24
    v_dot2_f32_bf16 v24, v75, v11, v24
    s_waitcnt vmcnt(2)
    buffer_load_dwordx4 v[44:47], v2, s[36:39], s54 offen offset:1024 nt
    v_dot2_f32_bf16 v25, v76, v8, 0
    v_dot2_f32_bf16 v25, v77, v9, v25
    v_dot2_f32_bf16 v25, v78, v10, v25
    v_dot2_f32_bf16 v25, v79, v11, v25
    v_add_f32_dpp v26, v24, v24 row_ror:8 row_mask:0xf bank_mask:0x3
    s_nop 1
    v_add_f32_dpp v26, v25, v25 row_ror:8 row_mask:0xf bank_mask:0xc
    s_waitcnt vmcnt(2)
    buffer_load_dwordx4 v[48:51], v2, s[36:39], s54 offen offset:2048 nt
    v_dot2_f32_bf16 v24, v80, v8, 0
    v_dot2_f32_bf16 v24, v81, v9, v24
    v_dot2_f32_bf16 v24, v82, v10, v24
    v_dot2_f32_bf16 v24, v83, v11, v24
    s_waitcnt vmcnt(2)
    buffer_load_dwordx4 v[116:119], v39, s[44:47], s55 offen offset:1152
    s_add_u32 s55, s55, 2304
    buffer_load_dwordx4 v[52:55], v2, s[36:39], s54 offen offset:3072 nt
    s_add_u32 s54, s54, 0x8000
    s_and_b32 s54, s54, 0xfffff
    v_dot2_f32_bf16 v25, v84, v8, 0
    v_dot2_f32_bf16 v25, v85, v9, v25
    v_dot2_f32_bf16 v25, v86, v10, v25
    v_dot2_f32_bf16 v25, v87, v11, v25
    v_add_f32_dpp v27, v24, v24 row_ror:8 row_mask:0xf bank_mask:0x3
    s_nop 1
    v_add_f32_dpp v27, v25, v25 row_ror:8 row_mask:0xf bank_mask:0xc
    v_add_f32_dpp v28, v26, v26 row_shl:4 row_mask:0xf bank_mask:0x5
    s_nop 1
    v_add_f32_dpp v28, v27, v27 row_shr:4 row_mask:0xf bank_mask:0xa
    s_waitcnt vmcnt(3)
    buffer_load_dwordx4 v[56:59], v2, s[36:39], s54 offen offset:0 nt
    v_dot2_f32_bf16 v24, v88, v8, 0
    v_dot2_f32_bf16 v24, v89, v9, v24
    v_dot2_f32_bf16 v24, v90, v10, v24
    v_dot2_f32_bf16 v24, v91, v11, v24
    s_waitcnt vmcnt(3)
    buffer_load_dwordx4 v[60:63], v2, s[36:39], s54 offen offset:1024 nt
    v_dot2_f32_bf16 v25, v92, v8, 0
    v_dot2_f32_bf16 v25, v93, v9, v25
    v_dot2_f32_bf16 v25, v94, v10, v25
    v_dot2_f32_bf16 v25, v95, v11, v25
    v_add_f32_dpp v26, v24, v24 row_ror:8 row_mask:0xf bank_mask:0x3
    s_nop 1
    v_add_f32_dpp v26, v25, v25 row_ror:8 row_mask:0xf bank_mask:0xc
    s_waitcnt vmcnt(2)
    buffer_load_dwordx4 v[64:67], v2, s[36:39], s54 offen offset:2048 nt
    v_dot2_f32_bf16 v24, v96, v8, 0
    v_dot2_f32_bf16 v24, v97, v9, v24
    v_dot2_f32_bf16 v24, v98, v10, v24
    v_dot2_f32_bf16 v24, v99, v11, v24
    s_memrealtime s[62:63]
    s_waitcnt vmcnt(2)
    buffer_load_dwordx4 v[68:71], v2, s[36:39], s54 offen offset:3072 nt
    s_add_u32 s54, s54, 0x8000
    s_and_b32 s54, s54, 0xfffff
    v_dot2_f32_bf16 v25, v100, v8, 0
    v_dot2_f32_bf16 v25, v101, v9, v25
    v_dot2_f32_bf16 v25, v102, v10, v25
    v_dot2_f32_bf16 v25, v103, v11, v25
    v_add_f32_dpp v27, v24, v24 row_ror:8 row_mask:0xf bank_mask:0x3
    s_nop 1
    v_add_f32_dpp v27, v25, v25 row_ror:8 row_mask:0xf bank_mask:0xc
    v_add_f32_dpp v29, v26, v26 row_shl:4 row_mask:0xf bank_mask:0x5
    s_nop 1
    v_add_f32_dpp v29, v27, v27 row_shr:4 row_mask:0xf bank_mask:0xa
    v_cndmask_b32 v32, v28, v29, s[58:59]
    v_cndmask_b32 v33, v29, v28, s[58:59]
    s_nop 1
    v_add_f32_dpp v31, v33, v32 quad_perm:[2,3,0,1] row_mask:0xf bank_mask:0xf
    v_cndmask_b32 v32, v30, v31, s[56:57]
    v_cndmask_b32 v33, v31, v30, s[56:57]
    s_nop 1
    v_add_f32_dpp v32, v33, v32 quad_perm:[1,0,3,2] row_mask:0xf bank_mask:0xf
    v_cvt_pk_bf16_f32 v32, v32, v32
    v_and_b32 v32, 0xffff0000, v32
    v_mul_f32 v32, 0x3db504f3, v32
    v_cvt_pk_bf16_f32 v19, v32, v32
    v_and_b32 v19, 0xffff0000, v19
    s_waitcnt lgkmcnt(0)
    s_cmp_lg_u32 s18, 0
    s_cselect_b32 s33, 240, 0
    s_add_u32 s18, s18, s33
    s_sub_u32 s33, s62, s18
    s_cmp_eq_u32 s18, 0
    s_cselect_b32 s33, 0, s33
    s_cmp_lg_u32 s15, 0
    s_cselect_b32 s33, 0, s33
    s_cmp_gt_i32 s33, 40
    s_cselect_b64 vcc, -1, 0
    s_cmp_gt_i32 s33, -40
    s_cselect_b32 s19, 1, 0
    s_mov_b32 s14, s62
    s_cmp_eq_u32 s15, 0
    s_cbranch_scc1 L_npk64
    s_cmp_lg_u32 s3, 0
    s_cbranch_scc1 L_npk64
    s_lshl2_add_u32 s33, s15, s71
    s_sub_u32 s33, s33, 4
    s_mov_b32 s34, s14
    s_atomic_swap s34, s[26:27], s33
L_npk64:
    s_sub_u32 s33, s71, 256
    s_load_dword s96, s[26:27], s33
    s_add_u32 s71, s71, 256
    s_waitcnt vmcnt(2)
    buffer_load_dwordx4 v[120:123], v39, s[44:47], s55 offen offset:0
    buffer_load_dwordx4 v[72:75], v2, s[36:39], s54 offen offset:0 nt
    v_dot2_f32_bf16 v24, v40, v8, 0
    v_dot2_f32_bf16 v24, v41, v9, v24
    v_dot2_f32_bf16 v24, v42, v10, v24
    v_dot2_f32_bf16 v24, v43, v11, v24
    s_waitcnt vmcnt(3)
    buffer_load_dwordx4 v[76:79], v2, s[36:39], s54 offen offset:1024 nt
    v_dot2_f32_bf16 v25, v44, v8, 0
    v_dot2_f32_bf16 v25, v45, v9, v25
    v_dot2_f32_bf16 v25, v46, v10, v25
    v_dot2_f32_bf16 v25, v47, v11, v25
    v_add_f32_dpp v26, v24, v24 row_ror:8 row_mask:0xf bank_mask:0x3
    s_nop 1
    v_add_f32_dpp v26, v25, v25 row_ror:8 row_mask:0xf bank_mask:0xc
    s_waitcnt vmcnt(3)
    buffer_load_dwordx4 v[80:83], v2, s[36:39], s54 offen offset:2048 nt
    v_dot2_f32_bf16 v24, v48, v8, 0
    v_dot2_f32_bf16 v24, v49, v9, v24
    v_dot2_f32_bf16 v24, v50, v10, v24
    v_dot2_f32_bf16 v24, v51, v11, v24
    s_waitcnt vmcnt(2)
    buffer_load_dwordx4 v[84:87], v2, s[36:39], s54 offen offset:3072 nt
    s_add_u32 s54, s54, 0x8000
    s_and_b32 s54, s54, 0xfffff
    v_dot2_f32_bf16 v25, v52, v8, 0
    v_dot2_f32_bf16 v25, v53, v9, v25
    v_dot2_f32_bf16 v25, v54, v10, v25
    v_dot2_f32_bf16 v25, v55, v11, v25
    v_add_f32_dpp v27, v24, v24 row_ror:8 row_mask:0xf bank_mask:0x3
    s_nop 1
    v_add_f32_dpp v27, v25, v25 row_ror:8 row_mask:0xf bank_mask:0xc
    v_add_f32_dpp v28, v26, v26 row_shl:4 row_mask:0xf bank_mask:0x5
    s_nop 1
    v_add_f32_dpp v28, v27, v27 row_shr:4 row_mask:0xf bank_mask:0xa
    s_waitcnt vmcnt(2)
    buffer_load_dwordx4 v[88:91], v2, s[36:39], s54 offen offset:0 nt
    v_dot2_f32_bf16 v24, v56, v8, 0
    v_dot2_f32_bf16 v24, v57, v9, v24
    v_dot2_f32_bf16 v24, v58, v10, v24
    v_dot2_f32_bf16 v24, v59, v11, v24
    s_waitcnt vmcnt(2)
    buffer_load_dwordx4 v[124:127], v39, s[44:47], s55 offen offset:1152
    s_add_u32 s55, s55, 2304
    buffer_load_dwordx4 v[92:95], v2, s[36:39], s54 offen offset:1024 nt
    v_dot2_f32_bf16 v25, v60, v8, 0
    v_dot2_f32_bf16 v25, v61, v9, v25
    v_dot2_f32_bf16 v25, v62, v10, v25
    v_dot2_f32_bf16 v25, v63, v11, v25
    v_add_f32_dpp v26, v24, v24 row_ror:8 row_mask:0xf bank_mask:0x3
    s_nop 1
    v_add_f32_dpp v26, v25, v25 row_ror:8 row_mask:0xf bank_mask:0xc
    s_waitcnt vmcnt(3)
    buffer_load_dwordx4 v[96:99], v2, s[36:39], s54 offen offset:2048 nt
    v_dot2_f32_bf16 v24, v64, v8, 0
    v_dot2_f32_bf16 v24, v65, v9, v24
    v_dot2_f32_bf16 v24, v66, v10, v24
    v_dot2_f32_bf16 v24, v67, v11, v24
    s_memrealtime s[62:63]
    s_waitcnt vmcnt(3)
    buffer_load_dwordx4 v[100:103], v2, s[36:39], s54 offen offset:3072 nt
    s_add_u32 s54, s54, 0x8000
    s_and_b32 s54, s54, 0xfffff
    v_dot2_f32_bf16 v25, v68, v8, 0
    v_dot2_f32_bf16 v25, v69, v9, v25
    v_dot2_f32_bf16 v25, v70, v10, v25
    v_dot2_f32_bf16 v25, v71, v11, v25
    v_add_f32_dpp v27, v24, v24 row_ror:8 row_mask:0xf bank_mask:0x3
    s_nop 1
    v_add_f32_dpp v27, v25, v25 row_ror:8 row_mask:0xf bank_mask:0xc
    v_add_f32_dpp v29, v26, v26 row_shl:4 row_mask:0xf bank_mask:0x5
    s_nop 1
    v_add_f32_dpp v29, v27, v27 row_shr:4 row_mask:0xf bank_mask:0xa
    v_cndmask_b32 v32, v28, v29, s[58:59]
    v_cndmask_b32 v33, v29, v28, s[58:59]
    s_nop 1
    v_add_f32_dpp v30, v33, v32 quad_perm:[2,3,0,1] row_mask:0xf bank_mask:0xf
    s_waitcnt lgkmcnt(0)
    s_cmp_lg_u32 s18, 0
    s_cselect_b32 s33, 240, 0
    s_add_u32 s18, s18, s33
    s_sub_u32 s34, s96, s17
    s_add_u32 s33, s96, 720
    s_cmp_lt_u32 s34, 0x8000
    s_cselect_b32 s18, s33, s18
    s_sub_u32 s33, s62, s18
    s_cmp_eq_u32 s18, 0
    s_cselect_b32 s33, 0, s33
    s_cmp_lg_u32 s15, 0
    s_cselect_b32 s33, 0, s33
    s_cmp_gt_i32 s33, 40
    s_cselect_b64 vcc, -1, 0
    s_cmp_gt_i32 s33, -40
    s_cselect_b32 s19, 1, 0
    s_cbranch_vccnz L_wb3
    s_cmp_lg_u32 s19, 0
    s_cbranch_scc1 L_wm3
    s_waitcnt vmcnt(1)
L_wm3:
    s_waitcnt vmcnt(2)
L_wb3:
    s_waitcnt vmcnt(4)
    buffer_load_dwordx4 v[40:43], v2, s[36:39], s54 offen offset:0 nt
    v_dot2_f32_bf16 v24, v72, v8, 0
    v_dot2_f32_bf16 v24, v73, v9, v24
    v_dot2_f32_bf16 v24, v74, v10, v24
    v_dot2_f32_bf16 v24, v75, v11, v24
    s_cbranch_vccnz L_wb4
    s_cmp_lg_u32 s19, 0
    s_cbranch_scc1 L_wm4
    s_waitcnt vmcnt(1)
L_wm4:
    s_waitcnt vmcnt(2)
L_wb4:
    s_waitcnt vmcnt(3)
    buffer_load_dwordx4 v[44:47], v2, s[36:39], s54 offen offset:1024 nt
    v_dot2_f32_bf16 v25, v76, v8, 0
    v_dot2_f32_bf16 v25, v77, v9, v25
    v_dot2_f32_bf16 v25, v78, v10, v25
    v_dot2_f32_bf16 v25, v79, v11, v25
    v_add_f32_dpp v26, v24, v24 row_ror:8 row_mask:0xf bank_mask:0x3
    s_nop 1
    v_add_f32_dpp v26, v25, v25 row_ror:8 row_mask:0xf bank_mask:0xc
    s_cbranch_vccnz L_wb5
    s_cmp_lg_u32 s19, 0
    s_cbranch_scc1 L_wm5
    s_waitcnt vmcnt(1)
L_wm5:
    s_waitcnt vmcnt(2)
L_wb5:
    s_waitcnt vmcnt(3)
    buffer_load_dwordx4 v[128:131], v39, s[44:47], s55 offen offset:0
    buffer_load_dwordx4 v[48:51], v2, s[36:39], s54 offen offset:2048 nt
    v_dot2_f32_bf16 v24, v80, v8, 0
    v_dot2_f32_bf16 v24, v81, v9, v24
    v_dot2_f32_bf16 v24, v82, v10, v24
    v_dot2_f32_bf16 v24, v83, v11, v24
    s_cbranch_vccnz L_wb6
    s_cmp_lg_u32 s19, 0
    s_cbranch_scc1 L_wm6
    s_waitcnt vmcnt(2)
L_wm6:
    s_waitcnt vmcnt(3)
L_wb6:
    s_waitcnt vmcnt(4)
    buffer_load_dwordx4 v[52:55], v2, s[36:39], s54 offen offset:3072 nt
    s_add_u32 s54, s54, 0x8000
    s_and_b32 s54, s54, 0xfffff
    v_dot2_f32_bf16 v25, v84, v8, 0
    v_dot2_f32_bf16 v25, v85, v9, v25
    v_dot2_f32_bf16 v25, v86, v10, v25
    v_dot2_f32_bf16 v25, v87, v11, v25
    v_add_f32_dpp v27, v24, v24 row_ror:8 row_mask:0xf bank_mask:0x3
    s_nop 1
    v_add_f32_dpp v27, v25, v25 row_ror:8 row_mask:0xf bank_mask:0xc
    v_add_f32_dpp v28, v26, v26 row_shl:4 row_mask:0xf bank_mask:0x5
    s_nop 1
    v_add_f32_dpp v28, v27, v27 row_shr:4 row_mask:0xf bank_mask:0xa
    s_cbranch_vccnz L_wb7
    s_cmp_lg_u32 s19, 0
    s_cbranch_scc1 L_wm7
    s_waitcnt vmcnt(1)
L_wm7:
    s_waitcnt vmcnt(3)
L_wb7:
    s_waitcnt vmcnt(4)
    buffer_load_dwordx4 v[56:59], v2, s[36:39], s54 offen offset:0 nt
    v_dot2_f32_bf16 v24, v88, v8, 0
    v_dot2_f32_bf16 v24, v89, v9, v24
    v_dot2_f32_bf16 v24, v90, v10, v24
    v_dot2_f32_bf16 v24, v91, v11, v24
    s_cbranch_vccnz L_wb8
    s_cmp_lg_u32 s19, 0
    s_cbranch_scc1 L_wm8
    s_waitcnt vmcnt(1)
L_wm8:
    s_waitcnt vmcnt(2)
L_wb8:
    s_waitcnt vmcnt(4)
    buffer_load_dwordx4 v[60:63], v2, s[36:39], s54 offen offset:1024 nt
    v_dot2_f32_bf16 v25, v92, v8, 0
    v_dot2_f32_bf16 v25, v93, v9, v25
    v_dot2_f32_bf16 v25, v94, v10, v25
    v_dot2_f32_bf16 v25, v95, v11, v25
    v_add_f32_dpp v26, v24, v24 row_ror:8 row_mask:0xf bank_mask:0x3
    s_nop 1
    v_add_f32_dpp v26, v25, v25 row_ror:8 row_mask:0xf bank_mask:0xc
    s_cbranch_vccnz L_wb9
    s_cmp_lg_u32 s19, 0
    s_cbranch_scc1 L_wm9
    s_waitcnt vmcnt(1)
L_wm9:
    s_waitcnt vmcnt(2)
L_wb9:
    s_waitcnt vmcnt(3)
    buffer_load_dwordx4 v[64:67], v2, s[36:39], s54 offen offset:2048 nt
    v_dot2_f32_bf16 v24, v96, v8, 0
    v_dot2_f32_bf16 v24, v97, v9, v24
    v_dot2_f32_bf16 v24, v98, v10, v24
    v_dot2_f32_bf16 v24, v99, v11, v24
    s_memrealtime s[62:63]
    s_cbranch_vccnz L_wb10
    s_cmp_lg_u32 s19, 0
    s_cbranch_scc1 L_wm10
    s_waitcnt vmcnt(1)
L_wm10:
    s_waitcnt vmcnt(2)
L_wb10:
    s_waitcnt vmcnt(3)
    buffer_load_dwordx4 v[132:135], v39, s[44:47], s55 offen offset:1152
    s_add_u32 s55, s55, 66816
    buffer_load_dwordx4 v[68:71], v2, s[36:39], s54 offen offset:3072 nt
    s_add_u32 s54, s54, 0x8000
    s_and_b32 s54, s54, 0xfffff
    v_dot2_f32_bf16 v25, v100, v8, 0
    v_dot2_f32_bf16 v25, v101, v9, v25
    v_dot2_f32_bf16 v25, v102, v10, v25
    v_dot2_f32_bf16 v25, v103, v11, v25
    v_add_f32_dpp v27, v24, v24 row_ror:8 row_mask:0xf bank_mask:0x3
    s_nop 1
    v_add_f32_dpp v27, v25, v25 row_ror:8 row_mask:0xf bank_mask:0xc
    v_add_f32_dpp v29, v26, v26 row_shl:4 row_mask:0xf bank_mask:0x5
    s_nop 1
    v_add_f32_dpp v29, v27, v27 row_shr:4 row_mask:0xf bank_mask:0xa
    v_cndmask_b32 v32, v28, v29, s[58:59]
    v_cndmask_b32 v33, v29, v28, s[58:59]
    s_nop 1
    v_add_f32_dpp v31, v33, v32 quad_perm:[2,3,0,1] row_mask:0xf bank_mask:0xf
    v_cndmask_b32 v32, v30, v31, s[56:57]
    v_cndmask_b32 v33, v31, v30, s[56:57]
    s_nop 1
    v_add_f32_dpp v32, v33, v32 quad_perm:[1,0,3,2] row_mask:0xf bank_mask:0xf
    v_cvt_pk_bf16_f32 v32, v32, v32
    v_and_b32 v32, 0xffff0000, v32
    v_mul_f32 v32, 0x3db504f3, v32
    v_cvt_pk_bf16_f32 v12, v32, v32
    v_and_b32 v12, 0xffff0000, v12
    s_waitcnt lgkmcnt(0)
    s_cmp_lg_u32 s18, 0
    s_cselect_b32 s33, 240, 0
    s_add_u32 s18, s18, s33
    s_sub_u32 s33, s62, s18
    s_cmp_eq_u32 s18, 0
    s_cselect_b32 s33, 0, s33
    s_cmp_lg_u32 s15, 0
    s_cselect_b32 s33, 0, s33
    s_cmp_gt_i32 s33, 40
    s_cselect_b64 vcc, -1, 0
    s_cmp_gt_i32 s33, -40
    s_cselect_b32 s19, 1, 0
    s_mov_b32 s14, s62
    s_cmp_eq_u32 s15, 0
    s_cbranch_scc1 L_npk80
    s_cmp_lg_u32 s3, 0
    s_cbranch_scc1 L_npk80
    s_lshl2_add_u32 s33, s15, s71
    s_sub_u32 s33, s33, 4
    s_mov_b32 s34, s14
    s_atomic_swap s34, s[26:27], s33
L_npk80:
    s_sub_u32 s33, s71, 256
    s_load_dword s96, s[26:27], s33
    s_add_u32 s71, s71, 256
    s_cbranch_vccnz L_wb12
    s_cmp_lg_u32 s19, 0
    s_cbranch_scc1 L_wm12
    s_waitcnt vmcnt(2)
L_wm12:
    s_waitcnt vmcnt(3)
L_wb12:
    s_waitcnt vmcnt(4)
    buffer_load_dwordx4 v[72:75], v2, s[36:39], s54 offen offset:0 nt
    v_dot2_f32_bf16 v24, v40, v8, 0
    v_dot2_f32_bf16 v24, v41, v9, v24
    v_dot2_f32_bf16 v24, v42, v10, v24
    v_dot2_f32_bf16 v24, v43, v11, v24
    s_cbranch_vccnz L_wb13
    s_cmp_lg_u32 s19, 0
    s_cbranch_scc1 L_wm13
    s_waitcnt vmcnt(1)
L_wm13:
    s_waitcnt vmcnt(3)
L_wb13:
    s_waitcnt vmcnt(4)
    buffer_load_dwordx4 v[76:79], v2, s[36:39], s54 offen offset:1024 nt
    v_dot2_f32_bf16 v25, v44, v8, 0
    v_dot2_f32_bf16 v25, v45, v9, v25
    v_dot2_f32_bf16 v25, v46, v10, v25
    v_dot2_f32_bf16 v25, v47, v11, v25
    v_add_f32_dpp v26, v24, v24 row_ror:8 row_mask:0xf bank_mask:0x3
    s_nop 1
    v_add_f32_dpp v26, v25, v25 row_ror:8 row_mask:0xf bank_mask:0xc
    s_cbranch_vccnz L_wb14
    s_cmp_lg_u32 s19, 0
    s_cbranch_scc1 L_wm14
    s_waitcnt vmcnt(1)
L_wm14:
    s_waitcnt vmcnt(2)
L_wb14:
    s_waitcnt vmcnt(4)
    buffer_load_dwordx4 v[80:83], v2, s[36:39], s54 offen offset:2048 nt
    v_dot2_f32_bf16 v24, v48, v8, 0
    v_dot2_f32_bf16 v24, v49, v9, v24
    v_dot2_f32_bf16 v24, v50, v10, v24
    v_dot2_f32_bf16 v24, v51, v11, v24
    s_cbranch_vccnz L_wb15
    s_cmp_lg_u32 s19, 0
    s_cbranch_scc1 L_wm15
    s_waitcnt vmcnt(1)
L_wm15:
    s_waitcnt vmcnt(2)
L_wb15:
    s_waitcnt vmcnt(3)
    buffer_load_dwordx4 v[84:87], v2, s[36:39], s54 offen offset:3072 nt
    s_add_u32 s54, s54, 0x8000
    s_and_b32 s54, s54, 0xfffff
    v_dot2_f32_bf16 v25, v52, v8, 0
    v_dot2_f32_bf16 v25, v53, v9, v25
    v_dot2_f32_bf16 v25, v54, v10, v25
    v_dot2_f32_bf16 v25, v55, v11, v25
    v_add_f32_dpp v27, v24, v24 row_ror:8 row_mask:0xf bank_mask:0x3
    s_nop 1
    v_add_f32_dpp v27, v25, v25 row_ror:8 row_mask:0xf bank_mask:0xc
    v_add_f32_dpp v28, v26, v26 row_shl:4 row_mask:0xf bank_mask:0x5
    s_nop 1
    v_add_f32_dpp v28, v27, v27 row_shr:4 row_mask:0xf bank_mask:0xa
    s_cbranch_vccnz L_wb16
    s_cmp_lg_u32 s19, 0
    s_cbranch_scc1 L_wm16
    s_waitcnt vmcnt(1)
L_wm16:
    s_waitcnt vmcnt(2)
L_wb16:
    s_waitcnt vmcnt(3)
    buffer_load_dwordx4 v[136:139], v39, s[44:47], s55 offen offset:0
    buffer_load_dwordx4 v[88:91], v2, s[36:39], s54 offen offset:0 nt
    v_dot2_f32_bf16 v24, v56, v8, 0
    v_dot2_f32_bf16 v24, v57, v9, v24
    v_dot2_f32_bf16 v24, v58, v10, v24
    v_dot2_f32_bf16 v24, v59, v11, v24
    s_cbranch_vccnz L_wb17
    s_cmp_lg_u32 s19, 0
    s_cbranch_scc1 L_wm17
    s_waitcnt vmcnt(2)
L_wm17:
    s_waitcnt vmcnt(3)
L_wb17:
    s_waitcnt vmcnt(4)
    buffer_load_dwordx4 v[92:95], v2, s[36:39], s54 offen offset:1024 nt
    v_dot2_f32_bf16 v25, v60, v8, 0
    v_dot2_f32_bf16 v25, v61, v9, v25
    v_dot2_f32_bf16 v25, v62, v10, v25
    v_dot2_f32_bf16 v25, v63, v11, v25
    v_add_f32_dpp v26, v24, v24 row_ror:8 row_mask:0xf bank_mask:0x3
    s_nop 1
    v_add_f32_dpp v26, v25, v25 row_ror:8 row_mask:0xf bank_mask:0xc
    s_cbranch_vccnz L_wb18
    s_cmp_lg_u32 s19, 0
    s_cbranch_scc1 L_wm18
    s_waitcnt vmcnt(1)
L_wm18:
    s_waitcnt vmcnt(3)
L_wb18:
    s_waitcnt vmcnt(4)
    buffer_load_dwordx4 v[96:99], v2, s[36:39], s54 offen offset:2048 nt
    v_dot2_f32_bf16 v24, v64, v8, 0
    v_dot2_f32_bf16 v24, v65, v9, v24
    v_dot2_f32_bf16 v24, v66, v10, v24
    v_dot2_f32_bf16 v24, v67, v11, v24
    s_memrealtime s[62:63]
    s_cbranch_vccnz L_wb19
    s_cmp_lg_u32 s19, 0
    s_cbranch_scc1 L_wm19
    s_waitcnt vmcnt(1)
L_wm19:
    s_waitcnt vmcnt(2)
L_wb19:
    s_waitcnt vmcnt(4)
    buffer_load_dwordx4 v[100:103], v2, s[36:39], s54 offen offset:3072 nt
    s_add_u32 s54, s54, 0x8000
    s_and_b32 s54, s54, 0xfffff
    v_dot2_f32_bf16 v25, v68, v8, 0
    v_dot2_f32_bf16 v25, v69, v9, v25
    v_dot2_f32_bf16 v25, v70, v10, v25
    v_dot2_f32_bf16 v25, v71, v11, v25
    v_add_f32_dpp v27, v24, v24 row_ror:8 row_mask:0xf bank_mask:0x3
    s_nop 1
    v_add_f32_dpp v27, v25, v25 row_ror:8 row_mask:0xf bank_mask:0xc
    v_add_f32_dpp v29, v26, v26 row_shl:4 row_mask:0xf bank_mask:0x5
    s_nop 1
    v_add_f32_dpp v29, v27, v27 row_shr:4 row_mask:0xf bank_mask:0xa
    v_cndmask_b32 v32, v28, v29, s[58:59]
    v_cndmask_b32 v33, v29, v28, s[58:59]
    s_nop 1
    v_add_f32_dpp v30, v33, v32 quad_perm:[2,3,0,1] row_mask:0xf bank_mask:0xf
    s_waitcnt lgkmcnt(0)
    s_cmp_lg_u32 s18, 0
    s_cselect_b32 s33, 240, 0
    s_add_u32 s18, s18, s33
    s_sub_u32 s34, s96, s17
    s_add_u32 s33, s96, 720
    s_cmp_lt_u32 s34, 0x8000
    s_cselect_b32 s18, s33, s18
    s_sub_u32 s33, s62, s18
    s_cmp_eq_u32 s18, 0
    s_cselect_b32 s33, 0, s33
    s_cmp_lg_u32 s15, 0
    s_cselect_b32 s33, 0, s33
    s_cmp_gt_i32 s33, 40
    s_cselect_b64 vcc, -1, 0
    s_cmp_gt_i32 s33, -40
    s_cselect_b32 s19, 1, 0
    s_cbranch_vccnz L_wb21
    s_cmp_lg_u32 s19, 0
    s_cbranch_scc1 L_wm21
    s_waitcnt vmcnt(1)
L_wm21:
    s_waitcnt vmcnt(2)
L_wb21:
    s_waitcnt vmcnt(3)
    buffer_load_dwordx4 v[40:43], v2, s[36:39], s54 offen offset:0 nt
    v_dot2_f32_bf16 v24, v72, v8, 0
    v_dot2_f32_bf16 v24, v73, v9, v24
    v_dot2_f32_bf16 v24, v74, v10, v24
    v_dot2_f32_bf16 v24, v75, v11, v24
    s_cbranch_vccnz L_wb22
    s_cmp_lg_u32 s19, 0
    s_cbranch_scc1 L_wm22
    s_waitcnt vmcnt(1)
L_wm22:
    s_waitcnt vmcnt(2)
L_wb22:
    s_waitcnt vmcnt(3)
    buffer_load_dwordx4 v[140:143], v39, s[44:47], s55 offen offset:1152
    s_add_u32 s55, s55, 2304
    buffer_load_dwordx4 v[44:47], v2, s[36:39], s54 offen offset:1024 nt
    v_dot2_f32_bf16 v25, v76, v8, 0
    v_dot2_f32_bf16 v25, v77, v9, v25
    v_dot2_f32_bf16 v25, v78, v10, v25
    v_dot2_f32_bf16 v25, v79, v11, v25
    v_add_f32_dpp v26, v24, v24 row_ror:8 row_mask:0xf bank_mask:0x3
    s_nop 1
    v_add_f32_dpp v26, v25, v25 row_ror:8 row_mask:0xf bank_mask:0xc
    s_cbranch_vccnz L_wb23
    s_cmp_lg_u32 s19, 0
    s_cbranch_scc1 L_wm23
    s_waitcnt vmcnt(2)
L_wm23:
    s_waitcnt vmcnt(3)
L_wb23:
    s_waitcnt vmcnt(4)
    buffer_load_dwordx4 v[48:51], v2, s[36:39], s54 offen offset:2048 nt
    v_dot2_f32_bf16 v24, v80, v8, 0
    v_dot2_f32_bf16 v24, v81, v9, v24
    v_dot2_f32_bf16 v24, v82, v10, v24
    v_dot2_f32_bf16 v24, v83, v11, v24
    s_cbranch_vccnz L_wb24
    s_cmp_lg_u32 s19, 0
    s_cbranch_scc1 L_wm24
    s_waitcnt vmcnt(1)
L_wm24:
    s_waitcnt vmcnt(3)
L_wb24:
    s_waitcnt vmcnt(4)
    buffer_load_dwordx4 v[52:55], v2, s[36:39], s54 offen offset:3072 nt
    s_add_u32 s54, s54, 0x8000
    s_and_b32 s54, s54, 0xfffff
    v_dot2_f32_bf16 v25, v84, v8, 0
    v_dot2_f32_bf16 v25, v85, v9, v25
    v_dot2_f32_bf16 v25, v86, v10, v25
    v_dot2_f32_bf16 v25, v87, v11, v25
    v_add_f32_dpp v27, v24, v24 row_ror:8 row_mask:0xf bank_mask:0x3
    s_nop 1
    v_add_f32_dpp v27, v25, v25 row_ror:8 row_mask:0xf bank_mask:0xc
    v_add_f32_dpp v28, v26, v26 row_shl:4 row_mask:0xf bank_mask:0x5
    s_nop 1
    v_add_f32_dpp v28, v27, v27 row_shr:4 row_mask:0xf bank_mask:0xa
    s_cbranch_vccnz L_wb25
    s_cmp_lg_u32 s19, 0
    s_cbranch_scc1 L_wm25
    s_waitcnt vmcnt(1)
L_wm25:
    s_waitcnt vmcnt(2)
L_wb25:
    s_waitcnt vmcnt(4)
    buffer_load_dwordx4 v[56:59], v2, s[36:39], s54 offen offset:0 nt
    v_dot2_f32_bf16 v24, v88, v8, 0
    v_dot2_f32_bf16 v24, v89, v9, v24
    v_dot2_f32_bf16 v24, v90, v10, v24
    v_dot2_f32_bf16 v24, v91, v11, v24
    s_cbranch_vccnz L_wb26
    s_cmp_lg_u32 s19, 0
    s_cbranch_scc1 L_wm26
    s_waitcnt vmcnt(1)
L_wm26:
    s_waitcnt vmcnt(2)
L_wb26:
    s_waitcnt vmcnt(3)
    buffer_load_dwordx4 v[60:63], v2, s[36:39], s54 offen offset:1024 nt
    v_dot2_f32_bf16 v25, v92, v8, 0
    v_dot2_f32_bf16 v25, v93, v9, v25
    v_dot2_f32_bf16 v25, v94, v10, v25
    v_dot2_f32_bf16 v25, v95, v11, v25
    v_add_f32_dpp v26, v24, v24 row_ror:8 row_mask:0xf bank_mask:0x3
    s_nop 1
    v_add_f32_dpp v26, v25, v25 row_ror:8 row_mask:0xf bank_mask:0xc
    s_cbranch_vccnz L_wb27
    s_cmp_lg_u32 s19, 0
    s_cbranch_scc1 L_wm27
    s_waitcnt vmcnt(1)
L_wm27:
    s_waitcnt vmcnt(2)
L_wb27:
    s_waitcnt vmcnt(3)
    buffer_load_dwordx4 v[144:147], v39, s[44:47], s55 offen offset:0
    buffer_load_dwordx4 v[64:67], v2, s[36:39], s54 offen offset:2048 nt
    v_dot2_f32_bf16 v24, v96, v8, 0
    v_dot2_f32_bf16 v24, v97, v9, v24
    v_dot2_f32_bf16 v24, v98, v10, v24
    v_dot2_f32_bf16 v24, v99, v11, v24
    s_memrealtime s[62:63]
    s_cbranch_vccnz L_wb28
    s_cmp_lg_u32 s19, 0
    s_cbranch_scc1 L_wm28
    s_waitcnt vmcnt(2)
L_wm28:
    s_waitcnt vmcnt(3)
L_wb28:
    s_waitcnt vmcnt(4)
    buffer_load_dwordx4 v[68:71], v2, s[36:39], s54 offen offset:3072 nt
    s_add_u32 s54, s54, 0x8000
    s_and_b32 s54, s54, 0xfffff
    v_dot2_f32_bf16 v25, v100, v8, 0
    v_dot2_f32_bf16 v25, v101, v9, v25
    v_dot2_f32_bf16 v25, v102, v10, v25
    v_dot2_f32_bf16 v25, v103, v11, v25
    v_add_f32_dpp v27, v24, v24 row_ror:8 row_mask:0xf bank_mask:0x3
    s_nop 1
    v_add_f32_dpp v27, v25, v25 row_ror:8 row_mask:0xf bank_mask:0xc
    v_add_f32_dpp v29, v26, v26 row_shl:4 row_mask:0xf bank_mask:0x5
    s_nop 1
    v_add_f32_dpp v29, v27, v27 row_shr:4 row_mask:0xf bank_mask:0xa
    v_cndmask_b32 v32, v28, v29, s[58:59]
    v_cndmask_b32 v33, v29, v28, s[58:59]
    s_nop 1
    v_add_f32_dpp v31, v33, v32 quad_perm:[2,3,0,1] row_mask:0xf bank_mask:0xf
    v_cndmask_b32 v32, v30, v31, s[56:57]
    v_cndmask_b32 v33, v31, v30, s[56:57]
    s_nop 1
    v_add_f32_dpp v32, v33, v32 quad_perm:[1,0,3,2] row_mask:0xf bank_mask:0xf
    v_cvt_pk_bf16_f32 v32, v32, v32
    v_and_b32 v32, 0xffff0000, v32
    v_mul_f32 v32, 0x3db504f3, v32
    v_cvt_pk_bf16_f32 v13, v32, v32
    v_and_b32 v13, 0xffff0000, v13
    s_waitcnt lgkmcnt(0)
    s_cmp_lg_u32 s18, 0
    s_cselect_b32 s33, 240, 0
    s_add_u32 s18, s18, s33
    s_sub_u32 s33, s62, s18
    s_cmp_eq_u32 s18, 0
    s_cselect_b32 s33, 0, s33
    s_cmp_lg_u32 s15, 0
    s_cselect_b32 s33, 0, s33
    s_cmp_gt_i32 s33, 40
    s_cselect_b64 vcc, -1, 0
    s_cmp_gt_i32 s33, -40
    s_cselect_b32 s19, 1, 0
    s_mov_b32 s14, s62
    s_cmp_eq_u32 s15, 0
    s_cbranch_scc1 L_npk96
    s_cmp_lg_u32 s3, 0
    s_cbranch_scc1 L_npk96
    s_lshl2_add_u32 s33, s15, s71
    s_sub_u32 s33, s33, 4
    s_mov_b32 s34, s14
    s_atomic_swap s34, s[26:27], s33
L_npk96:
    s_sub_u32 s33, s71, 256
    s_load_dword s96, s[26:27], s33
    s_add_u32 s71, s71, 256
    s_cbranch_vccnz L_wb30
    s_cmp_lg_u32 s19, 0
    s_cbranch_scc1 L_wm30
    s_waitcnt vmcnt(1)
L_wm30:
    s_waitcnt vmcnt(3)
L_wb30:
    s_waitcnt vmcnt(4)
    buffer_load_dwordx4 v[72:75], v2, s[36:39], s54 offen offset:0 nt
    v_dot2_f32_bf16 v24, v40, v8, 0
    v_dot2_f32_bf16 v24, v41, v9, v24
    v_dot2_f32_bf16 v24, v42, v10, v24
    v_dot2_f32_bf16 v24, v43, v11, v24
    s_cbranch_vccnz L_wb31
    s_cmp_lg_u32 s19, 0
    s_cbranch_scc1 L_wm31
    s_waitcnt vmcnt(1)
L_wm31:
    s_waitcnt vmcnt(2)
L_wb31:
    s_waitcnt vmcnt(4)
    buffer_load_dwordx4 v[76:79], v2, s[36:39], s54 offen offset:1024 nt
    v_dot2_f32_bf16 v25, v44, v8, 0
    v_dot2_f32_bf16 v25, v45, v9, v25
    v_dot2_f32_bf16 v25, v46, v10, v25
    v_dot2_f32_bf16 v25, v47, v11, v25
    v_add_f32_dpp v26, v24, v24 row_ror:8 row_mask:0xf bank_mask:0x3
    s_nop 1
    v_add_f32_dpp v26, v25, v25 row_ror:8 row_mask:0xf bank_mask:0xc
    s_cbranch_vccnz L_wb32
    s_cmp_lg_u32 s19, 0
    s_cbranch_scc1 L_wm32
    s_waitcnt vmcnt(1)
L_wm32:
    s_waitcnt vmcnt(2)
L_wb32:
    s_waitcnt vmcnt(3)
    buffer_load_dwordx4 v[80:83], v2, s[36:39], s54 offen offset:2048 nt
    v_dot2_f32_bf16 v24, v48, v8, 0
    v_dot2_f32_bf16 v24, v49, v9, v24
    v_dot2_f32_bf16 v24, v50, v10, v24
    v_dot2_f32_bf16 v24, v51, v11, v24
    s_cbranch_vccnz L_wb33
    s_cmp_lg_u32 s19, 0
    s_cbranch_scc1 L_wm33
    s_waitcnt vmcnt(1)
L_wm33:
    s_waitcnt vmcnt(2)
L_wb33:
    s_waitcnt vmcnt(3)
    buffer_load_dwordx4 v[148:151], v39, s[44:47], s55 offen offset:1152
    s_add_u32 s55, s55, 2304
    buffer_load_dwordx4 v[84:87], v2, s[36:39], s54 offen offset:3072 nt
    s_add_u32 s54, s54, 0x8000
    s_and_b32 s54, s54, 0xfffff
    v_dot2_f32_bf16 v25, v52, v8, 0
    v_dot2_f32_bf16 v25, v53, v9, v25
    v_dot2_f32_bf16 v25, v54, v10, v25
    v_dot2_f32_bf16 v25, v55, v11, v25
    v_add_f32_dpp v27, v24, v24 row_ror:8 row_mask:0xf bank_mask:0x3
    s_nop 1
    v_add_f32_dpp v27, v25, v25 row_ror:8 row_mask:0xf bank_mask:0xc
    v_add_f32_dpp v28, v26, v26 row_shl:4 row_mask:0xf bank_mask:0x5
    s_nop 1
    v_add_f32_dpp v28, v27, v27 row_shr:4 row_mask:0xf bank_mask:0xa
    s_cbranch_vccnz L_wb34
    s_cmp_lg_u32 s19, 0
    s_cbranch_scc1 L_wm34
    s_waitcnt vmcnt(2)
L_wm34:
    s_waitcnt vmcnt(3)
L_wb34:
    s_waitcnt vmcnt(4)
    buffer_load_dwordx4 v[88:91], v2, s[36:39], s54 offen offset:0 nt
    v_dot2_f32_bf16 v24, v56, v8, 0
    v_dot2_f32_bf16 v24, v57, v9, v24
    v_dot2_f32_bf16 v24, v58, v10, v24
    v_dot2_f32_bf16 v24, v59, v11, v24
    s_cbranch_vccnz L_wb35
    s_cmp_lg_u32 s19, 0
    s_cbranch_scc1 L_wm35
    s_waitcnt vmcnt(1)
L_wm35:
    s_waitcnt vmcnt(3)
L_wb35:
    s_waitcnt vmcnt(4)
    buffer_load_dwordx4 v[92:95], v2, s[36:39], s54 offen offset:1024 nt
    v_dot2_f32_bf16 v25, v60, v8, 0
    v_dot2_f32_bf16 v25, v61, v9, v25
    v_dot2_f32_bf16 v25, v62, v10, v25
    v_dot2_f32_bf16 v25, v63, v11, v25
    v_add_f32_dpp v26, v24, v24 row_ror:8 row_mask:0xf bank_mask:0x3
    s_nop 1
    v_add_f32_dpp v26, v25, v25 row_ror:8 row_mask:0xf bank_mask:0xc
    s_cbranch_vccnz L_wb36
    s_cmp_lg_u32 s19, 0
    s_cbranch_scc1 L_wm36
    s_waitcnt vmcnt(1)
L_wm36:
    s_waitcnt vmcnt(2)
L_wb36:
    s_waitcnt vmcnt(4)
    buffer_load_dwordx4 v[96:99], v2, s[36:39], s54 offen offset:2048 nt
    v_dot2_f32_bf16 v24, v64, v8, 0
    v_dot2_f32_bf16 v24, v65, v9, v24
    v_dot2_f32_bf16 v24, v66, v10, v24
    v_dot2_f32_bf16 v24, v67, v11, v24
    s_memrealtime s[62:63]
    s_cbranch_vccnz L_wb37
    s_cmp_lg_u32 s19, 0
    s_cbranch_scc1 L_wm37
    s_waitcnt vmcnt(1)
L_wm37:
    s_waitcnt vmcnt(2)
L_wb37:
    s_waitcnt vmcnt(3)
    buffer_load_dwordx4 v[100:103], v2, s[36:39], s54 offen offset:3072 nt
    s_add_u32 s54, s54, 0x8000
    s_and_b32 s54, s54, 0xfffff
    v_dot2_f32_bf16 v25, v68, v8, 0
    v_dot2_f32_bf16 v25, v69, v9, v25
    v_dot2_f32_bf16 v25, v70, v10, v25
    v_dot2_f32_bf16 v25, v71, v11, v25
    v_add_f32_dpp v27, v24, v24 row_ror:8 row_mask:0xf bank_mask:0x3
    s_nop 1
    v_add_f32_dpp v27, v25, v25 row_ror:8 row_mask:0xf bank_mask:0xc
    v_add_f32_dpp v29, v26, v26 row_shl:4 row_mask:0xf bank_mask:0x5
    s_nop 1
    v_add_f32_dpp v29, v27, v27 row_shr:4 row_mask:0xf bank_mask:0xa
    v_cndmask_b32 v32, v28, v29, s[58:59]
    v_cndmask_b32 v33, v29, v28, s[58:59]
    s_nop 1
    v_add_f32_dpp v30, v33, v32 quad_perm:[2,3,0,1] row_mask:0xf bank_mask:0xf
    s_waitcnt lgkmcnt(0)
    s_cmp_lg_u32 s18, 0
    s_cselect_b32 s33, 240, 0
    s_add_u32 s18, s18, s33
    s_sub_u32 s34, s96, s17
    s_add_u32 s33, s96, 720
    s_cmp_lt_u32 s34, 0x8000
    s_cselect_b32 s18, s33, s18
    s_sub_u32 s33, s62, s18
    s_cmp_eq_u32 s18, 0
    s_cselect_b32 s33, 0, s33
    s_cmp_lg_u32 s15, 0
    s_cselect_b32 s33, 0, s33
    s_cmp_gt_i32 s33, 40
    s_cselect_b64 vcc, -1, 0
    s_cmp_gt_i32 s33, -40
    s_cselect_b32 s19, 1, 0
    s_cbranch_vccnz L_wb39
    s_cmp_lg_u32 s19, 0
    s_cbranch_scc1 L_wm39
    s_waitcnt vmcnt(1)
L_wm39:
    s_waitcnt vmcnt(2)
L_wb39:
    s_waitcnt vmcnt(3)
    buffer_load_dwordx4 v[152:155], v39, s[44:47], s55 offen offset:0
    buffer_load_dwordx4 v[40:43], v2, s[36:39], s54 offen offset:0 nt
    v_dot2_f32_bf16 v24, v72, v8, 0
    v_dot2_f32_bf16 v24, v73, v9, v24
    v_dot2_f32_bf16 v24, v74, v10, v24
    v_dot2_f32_bf16 v24, v75, v11, v24
    s_cbranch_vccnz L_wb40
    s_cmp_lg_u32 s19, 0
    s_cbranch_scc1 L_wm40
    s_waitcnt vmcnt(2)
L_wm40:
    s_waitcnt vmcnt(3)
L_wb40:
    s_waitcnt vmcnt(4)
    buffer_load_dwordx4 v[44:47], v2, s[36:39], s54 offen offset:1024 nt
    v_dot2_f32_bf16 v25, v76, v8, 0
    v_dot2_f32_bf16 v25, v77, v9, v25
    v_dot2_f32_bf16 v25, v78, v10, v25
    v_dot2_f32_bf16 v25, v79, v11, v25
    v_add_f32_dpp v26, v24, v24 row_ror:8 row_mask:0xf bank_mask:0x3
    s_nop 1
    v_add_f32_dpp v26, v25, v25 row_ror:8 row_mask:0xf bank_mask:0xc
    s_cbranch_vccnz L_wb41
    s_cmp_lg_u32 s19, 0
    s_cbranch_scc1 L_wm41
    s_waitcnt vmcnt(1)
L_wm41:
    s_waitcnt vmcnt(3)
L_wb41:
    s_waitcnt vmcnt(4)
    buffer_load_dwordx4 v[48:51], v2, s[36:39], s54 offen offset:2048 nt
    v_dot2_f32_bf16 v24, v80, v8, 0
    v_dot2_f32_bf16 v24, v81, v9, v24
    v_dot2_f32_bf16 v24, v82, v10, v24
    v_dot2_f32_bf16 v24, v83, v11, v24
    s_cbranch_vccnz L_wb42
    s_cmp_lg_u32 s19, 0
    s_cbranch_scc1 L_wm42
    s_waitcnt vmcnt(1)
L_wm42:
    s_waitcnt vmcnt(2)
L_wb42:
    s_waitcnt vmcnt(4)
    buffer_load_dwordx4 v[52:55], v2, s[36:39], s54 offen offset:3072 nt
    s_add_u32 s54, s54, 0x8000
    s_and_b32 s54, s54, 0xfffff
    v_dot2_f32_bf16 v25, v84, v8, 0
    v_dot2_f32_bf16 v25, v85, v9, v25
    v_dot2_f32_bf16 v25, v86, v10, v25
    v_dot2_f32_bf16 v25, v87, v11, v25
    v_add_f32_dpp v27, v24, v24 row_ror:8 row_mask:0xf bank_mask:0x3
    s_nop 1
    v_add_f32_dpp v27, v25, v25 row_ror:8 row_mask:0xf bank_mask:0xc
    v_add_f32_dpp v28, v26, v26 row_shl:4 row_mask:0xf bank_mask:0x5
    s_nop 1
    v_add_f32_dpp v28, v27, v27 row_shr:4 row_mask:0xf bank_mask:0xa
    s_cbranch_vccnz L_wb43
    s_cmp_lg_u32 s19, 0
    s_cbranch_scc1 L_wm43
    s_waitcnt vmcnt(1)
L_wm43:
    s_waitcnt vmcnt(2)
L_wb43:
    s_waitcnt vmcnt(3)
    buffer_load_dwordx4 v[56:59], v2, s[36:39], s54 offen offset:0 nt
    v_dot2_f32_bf16 v24, v88, v8, 0
    v_dot2_f32_bf16 v24, v89, v9, v24
    v_dot2_f32_bf16 v24, v90, v10, v24
    v_dot2_f32_bf16 v24, v91, v11, v24
    s_cbranch_vccnz L_wb44
    s_cmp_lg_u32 s19, 0
    s_cbranch_scc1 L_wm44
    s_waitcnt vmcnt(1)
L_wm44:
    s_waitcnt vmcnt(2)
L_wb44:
    s_waitcnt vmcnt(3)
    buffer_load_dwordx4 v[156:159], v39, s[44:47], s55 offen offset:1152
    s_add_u32 s55, s55, 2304
    buffer_load_dwordx4 v[60:63], v2, s[36:39], s54 offen offset:1024 nt
    v_dot2_f32_bf16 v25, v92, v8, 0
    v_dot2_f32_bf16 v25, v93, v9, v25
    v_dot2_f32_bf16 v25, v94, v10, v25
    v_dot2_f32_bf16 v25, v95, v11, v25
    v_add_f32_dpp v26, v24, v24 row_ror:8 row_mask:0xf bank_mask:0x3
    s_nop 1
    v_add_f32_dpp v26, v25, v25 row_ror:8 row_mask:0xf bank_mask:0xc
    s_cbranch_vccnz L_wb45
    s_cmp_lg_u32 s19, 0
    s_cbranch_scc1 L_wm45
    s_waitcnt vmcnt(2)
L_wm45:
    s_waitcnt vmcnt(3)
L_wb45:
    s_waitcnt vmcnt(4)
    buffer_load_dwordx4 v[64:67], v2, s[36:39], s54 offen offset:2048 nt
    v_dot2_f32_bf16 v24, v96, v8, 0
    v_dot2_f32_bf16 v24, v97, v9, v24
    v_dot2_f32_bf16 v24, v98, v10, v24
    v_dot2_f32_bf16 v24, v99, v11, v24
    s_memrealtime s[62:63]
    s_cbranch_vccnz L_wb46
    s_cmp_lg_u32 s19, 0
    s_cbranch_scc1 L_wm46
    s_waitcnt vmcnt(1)
L_wm46:
    s_waitcnt vmcnt(3)
L_wb46:
    s_waitcnt vmcnt(4)
    buffer_load_dwordx4 v[68:71], v2, s[36:39], s54 offen offset:3072 nt
    s_add_u32 s54, s54, 0x8000
    s_and_b32 s54, s54, 0xfffff
    v_dot2_f32_bf16 v25, v100, v8, 0
    v_dot2_f32_bf16 v25, v101, v9, v25
    v_dot2_f32_bf16 v25, v102, v10, v25
    v_dot2_f32_bf16 v25, v103, v11, v25
    v_add_f32_dpp v27, v24, v24 row_ror:8 row_mask:0xf bank_mask:0x3
    s_nop 1
    v_add_f32_dpp v27, v25, v25 row_ror:8 row_mask:0xf bank_mask:0xc
    v_add_f32_dpp v29, v26, v26 row_shl:4 row_mask:0xf bank_mask:0x5
    s_nop 1
    v_add_f32_dpp v29, v27, v27 row_shr:4 row_mask:0xf bank_mask:0xa
    v_cndmask_b32 v32, v28, v29, s[58:59]
    v_cndmask_b32 v33, v29, v28, s[58:59]
    s_nop 1
    v_add_f32_dpp v31, v33, v32 quad_perm:[2,3,0,1] row_mask:0xf bank_mask:0xf
    v_cndmask_b32 v32, v30, v31, s[56:57]
    v_cndmask_b32 v33, v31, v30, s[56:57]
    s_nop 1
    v_add_f32_dpp v32, v33, v32 quad_perm:[1,0,3,2] row_mask:0xf bank_mask:0xf
    v_cvt_pk_bf16_f32 v32, v32, v32
    v_and_b32 v32, 0xffff0000, v32
    v_mul_f32 v32, 0x3db504f3, v32
    v_cvt_pk_bf16_f32 v14, v32, v32
    v_and_b32 v14, 0xffff0000, v14
    s_waitcnt lgkmcnt(0)
    s_cmp_lg_u32 s18, 0
    s_cselect_b32 s33, 240, 0
    s_add_u32 s18, s18, s33
    s_sub_u32 s33, s62, s18
    s_cmp_eq_u32 s18, 0
    s_cselect_b32 s33, 0, s33
    s_cmp_lg_u32 s15, 0
    s_cselect_b32 s33, 0, s33
    s_cmp_gt_i32 s33, 40
    s_cselect_b64 vcc, -1, 0
    s_cmp_gt_i32 s33, -40
    s_cselect_b32 s19, 1, 0
    s_mov_b32 s14, s62
    s_cmp_eq_u32 s15, 0
    s_cbranch_scc1 L_npk112
    s_cmp_lg_u32 s3, 0
    s_cbranch_scc1 L_npk112
    s_lshl2_add_u32 s33, s15, s71
    s_sub_u32 s33, s33, 4
    s_mov_b32 s34, s14
    s_atomic_swap s34, s[26:27], s33
L_npk112:
    s_sub_u32 s33, s71, 256
    s_load_dword s96, s[26:27], s33
    s_add_u32 s71, s71, 256
    s_cbranch_vccnz L_wb48
    s_cmp_lg_u32 s19, 0
    s_cbranch_scc1 L_wm48
    s_waitcnt vmcnt(1)
L_wm48:
    s_waitcnt vmcnt(2)
L_wb48:
    s_waitcnt vmcnt(4)
    buffer_load_dwordx4 v[72:75], v2, s[36:39], s54 offen offset:0 nt
    v_dot2_f32_bf16 v24, v40, v8, 0
    v_dot2_f32_bf16 v24, v41, v9, v24
    v_dot2_f32_bf16 v24, v42, v10, v24
    v_dot2_f32_bf16 v24, v43, v11, v24
    s_cbranch_vccnz L_wb49
    s_cmp_lg_u32 s19, 0
    s_cbranch_scc1 L_wm49
    s_waitcnt vmcnt(1)
L_wm49:
    s_waitcnt vmcnt(2)
L_wb49:
    s_waitcnt vmcnt(3)
    buffer_load_dwordx4 v[76:79], v2, s[36:39], s54 offen offset:1024 nt
    v_dot2_f32_bf16 v25, v44, v8, 0
    v_dot2_f32_bf16 v25, v45, v9, v25
    v_dot2_f32_bf16 v25, v46, v10, v25
    v_dot2_f32_bf16 v25, v47, v11, v25
    v_add_f32_dpp v26, v24, v24 row_ror:8 row_mask:0xf bank_mask:0x3
    s_nop 1
    v_add_f32_dpp v26, v25, v25 row_ror:8 row_mask:0xf bank_mask:0xc
    s_cbranch_vccnz L_wb50
    s_cmp_lg_u32 s19, 0
    s_cbranch_scc1 L_wm50
    s_waitcnt vmcnt(1)
L_wm50:
    s_waitcnt vmcnt(2)
L_wb50:
    s_waitcnt vmcnt(3)
    buffer_load_dwordx4 v[160:163], v39, s[44:47], s55 offen offset:0
    buffer_load_dwordx4 v[80:83], v2, s[36:39], s54 offen offset:2048 nt
    v_dot2_f32_bf16 v24, v48, v8, 0
    v_dot2_f32_bf16 v24, v49, v9, v24
    v_dot2_f32_bf16 v24, v50, v10, v24
    v_dot2_f32_bf16 v24, v51, v11, v24
    s_cbranch_vccnz L_wb51
    s_cmp_lg_u32 s19, 0
    s_cbranch_scc1 L_wm51
    s_waitcnt vmcnt(2)
L_wm51:
    s_waitcnt vmcnt(3)
L_wb51:
    s_waitcnt vmcnt(4)
    buffer_load_dwordx4 v[84:87], v2, s[36:39], s54 offen offset:3072 nt
    s_add_u32 s54, s54, 0x8000
    s_and_b32 s54, s54, 0xfffff
    v_dot2_f32_bf16 v25, v52, v8, 0
    v_dot2_f32_bf16 v25, v53, v9, v25
    v_dot2_f32_bf16 v25, v54, v10, v25
    v_dot2_f32_bf16 v25, v55, v11, v25
    v_add_f32_dpp v27, v24, v24 row_ror:8 row_mask:0xf bank_mask:0x3
    s_nop 1
    v_add_f32_dpp v27, v25, v25 row_ror:8 row_mask:0xf bank_mask:0xc
    v_add_f32_dpp v28, v26, v26 row_shl:4 row_mask:0xf bank_mask:0x5
    s_nop 1
    v_add_f32_dpp v28, v27, v27 row_shr:4 row_mask:0xf bank_mask:0xa
    s_cbranch_vccnz L_wb52
    s_cmp_lg_u32 s19, 0
    s_cbranch_scc1 L_wm52
    s_waitcnt vmcnt(1)
L_wm52:
    s_waitcnt vmcnt(3)
L_wb52:
    s_waitcnt vmcnt(4)
    buffer_load_dwordx4 v[88:91], v2, s[36:39], s54 offen offset:0 nt
    v_dot2_f32_bf16 v24, v56, v8, 0
    v_dot2_f32_bf16 v24, v57, v9, v24
    v_dot2_f32_bf16 v24, v58, v10, v24
    v_dot2_f32_bf16 v24, v59, v11, v24
    s_cbranch_vccnz L_wb53
    s_cmp_lg_u32 s19, 0
    s_cbranch_scc1 L_wm53
    s_waitcnt vmcnt(1)
L_wm53:
    s_waitcnt vmcnt(2)
L_wb53:
    s_waitcnt vmcnt(4)
    buffer_load_dwordx4 v[92:95], v2, s[36:39], s54 offen offset:1024 nt
    v_dot2_f32_bf16 v25, v60, v8, 0
    v_dot2_f32_bf16 v25, v61, v9, v25
    v_dot2_f32_bf16 v25, v62, v10, v25
    v_dot2_f32_bf16 v25, v63, v11, v25
    v_add_f32_dpp v26, v24, v24 row_ror:8 row_mask:0xf bank_mask:0x3
    s_nop 1
    v_add_f32_dpp v26, v25, v25 row_ror:8 row_mask:0xf bank_mask:0xc
    s_cbranch_vccnz L_wb54
    s_cmp_lg_u32 s19, 0
    s_cbranch_scc1 L_wm54
    s_waitcnt vmcnt(1)
L_wm54:
    s_waitcnt vmcnt(2)
L_wb54:
    s_waitcnt vmcnt(3)
    buffer_load_dwordx4 v[96:99], v2, s[36:39], s54 offen offset:2048 nt
    v_dot2_f32_bf16 v24, v64, v8, 0
    v_dot2_f32_bf16 v24, v65, v9, v24
    v_dot2_f32_bf16 v24, v66, v10, v24
    v_dot2_f32_bf16 v24, v67, v11, v24
    s_memrealtime s[62:63]
    s_cbranch_vccnz L_wb55
    s_cmp_lg_u32 s19, 0
    s_cbranch_scc1 L_wm55
    s_waitcnt vmcnt(1)
L_wm55:
    s_waitcnt vmcnt(2)
L_wb55:
    s_waitcnt vmcnt(3)
    buffer_load_dwordx4 v[164:167], v39, s[44:47], s55 offen offset:1152
    buffer_load_dwordx4 v[100:103], v2, s[36:39], s54 offen offset:3072 nt
    s_add_u32 s54, s54, 0x8000
    s_and_b32 s54, s54, 0xfffff
    s_mov_b32 s36, s52
    s_mov_b32 s37, s53
    v_dot2_f32_bf16 v25, v68, v8, 0
    v_dot2_f32_bf16 v25, v69, v9, v25
    v_dot2_f32_bf16 v25, v70, v10, v25
    v_dot2_f32_bf16 v25, v71, v11, v25
    v_add_f32_dpp v27, v24, v24 row_ror:8 row_mask:0xf bank_mask:0x3
    s_nop 1
    v_add_f32_dpp v27, v25, v25 row_ror:8 row_mask:0xf bank_mask:0xc
    v_add_f32_dpp v29, v26, v26 row_shl:4 row_mask:0xf bank_mask:0x5
    s_nop 1
    v_add_f32_dpp v29, v27, v27 row_shr:4 row_mask:0xf bank_mask:0xa
    v_cndmask_b32 v32, v28, v29, s[58:59]
    v_cndmask_b32 v33, v29, v28, s[58:59]
    s_nop 1
    v_add_f32_dpp v30, v33, v32 quad_perm:[2,3,0,1] row_mask:0xf bank_mask:0xf
    s_waitcnt lgkmcnt(0)
    s_cmp_lg_u32 s18, 0
    s_cselect_b32 s33, 240, 0
    s_add_u32 s18, s18, s33
    s_sub_u32 s34, s96, s17
    s_add_u32 s33, s96, 720
    s_cmp_lt_u32 s34, 0x8000
    s_cselect_b32 s18, s33, s18
    s_sub_u32 s33, s62, s18
    s_cmp_eq_u32 s18, 0
    s_cselect_b32 s33, 0, s33
    s_cmp_lg_u32 s15, 0
    s_cselect_b32 s33, 0, s33
    s_cmp_gt_i32 s33, 40
    s_cselect_b64 vcc, -1, 0
    s_cmp_gt_i32 s33, -40
    s_cselect_b32 s19, 1, 0
    s_cbranch_vccnz L_wb57
    s_cmp_lg_u32 s19, 0
    s_cbranch_scc1 L_wm57
    s_waitcnt vmcnt(2)
L_wm57:
    s_waitcnt vmcnt(3)
L_wb57:
    s_waitcnt vmcnt(4)
    buffer_load_dwordx4 v[40:43], v2, s[36:39], s54 offen offset:0 nt
    v_dot2_f32_bf16 v24, v72, v8, 0
    v_dot2_f32_bf16 v24, v73, v9, v24
    v_dot2_f32_bf16 v24, v74, v10, v24
    v_dot2_f32_bf16 v24, v75, v11, v24
    s_cbranch_vccnz L_wb58
    s_cmp_lg_u32 s19, 0
    s_cbranch_scc1 L_wm58
    s_waitcnt vmcnt(1)
L_wm58:
    s_waitcnt vmcnt(3)
L_wb58:
    s_waitcnt vmcnt(4)
    buffer_load_dwordx4 v[44:47], v2, s[36:39], s54 offen offset:1024 nt
    v_dot2_f32_bf16 v25, v76, v8, 0
    v_dot2_f32_bf16 v25, v77, v9, v25
    v_dot2_f32_bf16 v25, v78, v10, v25
    v_dot2_f32_bf16 v25, v79, v11, v25
    v_add_f32_dpp v26, v24, v24 row_ror:8 row_mask:0xf bank_mask:0x3
    s_nop 1
    v_add_f32_dpp v26, v25, v25 row_ror:8 row_mask:0xf bank_mask:0xc
    s_cbranch_vccnz L_wb59
    s_cmp_lg_u32 s19, 0
    s_cbranch_scc1 L_wm59
    s_waitcnt vmcnt(1)
L_wm59:
    s_waitcnt vmcnt(2)
L_wb59:
    s_waitcnt vmcnt(4)
    buffer_load_dwordx4 v[48:51], v2, s[36:39], s54 offen offset:2048 nt
    v_dot2_f32_bf16 v24, v80, v8, 0
    v_dot2_f32_bf16 v24, v81, v9, v24
    v_dot2_f32_bf16 v24, v82, v10, v24
    v_dot2_f32_bf16 v24, v83, v11, v24
    s_cbranch_vccnz L_wb60
    s_cmp_lg_u32 s19, 0
    s_cbranch_scc1 L_wm60
    s_waitcnt vmcnt(1)
L_wm60:
    s_waitcnt vmcnt(2)
L_wb60:
    s_waitcnt vmcnt(3)
    buffer_load_dwordx4 v[52:55], v2, s[36:39], s54 offen offset:3072 nt
    s_add_u32 s54, s54, 0x8000
    s_and_b32 s54, s54, 0xfffff
    v_dot2_f32_bf16 v25, v84, v8, 0
    v_dot2_f32_bf16 v25, v85, v9, v25
    v_dot2_f32_bf16 v25, v86, v10, v25
    v_dot2_f32_bf16 v25, v87, v11, v25
    v_add_f32_dpp v27, v24, v24 row_ror:8 row_mask:0xf bank_mask:0x3
    s_nop 1
    v_add_f32_dpp v27, v25, v25 row_ror:8 row_mask:0xf bank_mask:0xc
    v_add_f32_dpp v28, v26, v26 row_shl:4 row_mask:0xf bank_mask:0x5
    s_nop 1
    v_add_f32_dpp v28, v27, v27 row_shr:4 row_mask:0xf bank_mask:0xa
    s_cbranch_vccnz L_wb61
    s_cmp_lg_u32 s19, 0
    s_cbranch_scc1 L_wm61
    s_waitcnt vmcnt(1)
L_wm61:
    s_waitcnt vmcnt(2)
L_wb61:
    s_waitcnt vmcnt(3)
    buffer_load_dwordx4 v[56:59], v2, s[36:39], s54 offen offset:0 nt
    v_dot2_f32_bf16 v24, v88, v8, 0
    v_dot2_f32_bf16 v24, v89, v9, v24
    v_dot2_f32_bf16 v24, v90, v10, v24
    v_dot2_f32_bf16 v24, v91, v11, v24
    s_cbranch_vccnz L_wb62
    s_cmp_lg_u32 s19, 0
    s_cbranch_scc1 L_wm62
    s_waitcnt vmcnt(1)
L_wm62:
    s_waitcnt vmcnt(2)
L_wb62:
    s_waitcnt vmcnt(3)
    buffer_load_dwordx4 v[60:63], v2, s[36:39], s54 offen offset:1024 nt
    v_dot2_f32_bf16 v25, v92, v8, 0
    v_dot2_f32_bf16 v25, v93, v9, v25
    v_dot2_f32_bf16 v25, v94, v10, v25
    v_dot2_f32_bf16 v25, v95, v11, v25
    v_add_f32_dpp v26, v24, v24 row_ror:8 row_mask:0xf bank_mask:0x3
    s_nop 1
    v_add_f32_dpp v26, v25, v25 row_ror:8 row_mask:0xf bank_mask:0xc
    s_cbranch_vccnz L_wb63
    s_cmp_lg_u32 s19, 0
    s_cbranch_scc1 L_wm63
    s_waitcnt vmcnt(1)
L_wm63:
    s_waitcnt vmcnt(2)
L_wb63:
    s_waitcnt vmcnt(3)
    buffer_load_dwordx4 v[64:67], v2, s[36:39], s54 offen offset:2048 nt
    v_dot2_f32_bf16 v24, v96, v8, 0
    v_dot2_f32_bf16 v24, v97, v9, v24
    v_dot2_f32_bf16 v24, v98, v10, v24
    v_dot2_f32_bf16 v24, v99, v11, v24
    s_memrealtime s[62:63]
    s_cbranch_vccnz L_wb64
    s_cmp_lg_u32 s19, 0
    s_cbranch_scc1 L_wm64
    s_waitcnt vmcnt(1)
L_wm64:
    s_waitcnt vmcnt(2)
L_wb64:
    s_waitcnt vmcnt(3)
    buffer_load_dwordx4 v[68:71], v2, s[36:39], s54 offen offset:3072 nt
    s_add_u32 s54, s54, 0x8000
    s_and_b32 s54, s54, 0xfffff
    v_dot2_f32_bf16 v25, v100, v8, 0
    v_dot2_f32_bf16 v25, v101, v9, v25
    v_dot2_f32_bf16 v25, v102, v10, v25
    v_dot2_f32_bf16 v25, v103, v11, v25
    v_add_f32_dpp v27, v24, v24 row_ror:8 row_mask:0xf bank_mask:0x3
    s_nop 1
    v_add_f32_dpp v27, v25, v25 row_ror:8 row_mask:0xf bank_mask:0xc
    v_add_f32_dpp v29, v26, v26 row_shl:4 row_mask:0xf bank_mask:0x5
    s_nop 1
    v_add_f32_dpp v29, v27, v27 row_shr:4 row_mask:0xf bank_mask:0xa
    v_cndmask_b32 v32, v28, v29, s[58:59]
    v_cndmask_b32 v33, v29, v28, s[58:59]
    s_nop 1
    v_add_f32_dpp v31, v33, v32 quad_perm:[2,3,0,1] row_mask:0xf bank_mask:0xf
    v_cndmask_b32 v32, v30, v31, s[56:57]
    v_cndmask_b32 v33, v31, v30, s[56:57]
    s_nop 1
    v_add_f32_dpp v32, v33, v32 quad_perm:[1,0,3,2] row_mask:0xf bank_mask:0xf
    v_cvt_pk_bf16_f32 v32, v32, v32
    v_and_b32 v32, 0xffff0000, v32
    v_mul_f32 v32, 0x3db504f3, v32
    v_cvt_pk_bf16_f32 v15, v32, v32
    v_and_b32 v15, 0xffff0000, v15
    s_waitcnt vmcnt(3)
    buffer_load_dwordx4 v[72:75], v2, s[36:39], s54 offen offset:0 nt
    v_max3_f32 v24, v12, v13, v14
    v_max3_f32 v24, v24, v15, v16
    v_max3_f32 v24, v24, v17, v18
    v_max_f32 v24, v24, v19
    s_nop 1
    v_max_f32_dpp v24, v24, v24 row_ror:8 row_mask:0xf bank_mask:0xf
    s_nop 1
    v_max_f32_dpp v24, v24, v24 row_ror:4 row_mask:0xf bank_mask:0xf
    s_nop 1
    v_max_f32_dpp v24, v24, v24 row_ror:2 row_mask:0xf bank_mask:0xf
    s_nop 1
    v_max_f32_dpp v24, v24, v24 row_ror:1 row_mask:0xf bank_mask:0xf
    s_nop 1
    v_max_f32_dpp v24, v24, v24 row_bcast:15 row_mask:0xa bank_mask:0xf
    s_nop 1
    v_max_f32_dpp v24, v24, v24 row_bcast:31 row_mask:0xc bank_mask:0xf
    s_nop 0
    v_readlane_b32 s33, v24, 63
    s_waitcnt vmcnt(3)
    buffer_load_dwordx4 v[76:79], v2, s[36:39], s54 offen offset:1024 nt
    v_subrev_f32 v26, s33, v12
    v_subrev_f32 v27, s33, v13
    v_subrev_f32 v28, s33, v14
    v_subrev_f32 v29, s33, v15
    v_subrev_f32 v30, s33, v16
    v_subrev_f32 v31, s33, v17
    v_subrev_f32 v32, s33, v18
    v_subrev_f32 v33, s33, v19
    v_mul_f32 v26, 0x3fb8aa3b, v26
    v_mul_f32 v27, 0x3fb8aa3b, v27
    v_mul_f32 v28, 0x3fb8aa3b, v28
    v_mul_f32 v29, 0x3fb8aa3b, v29
    v_mul_f32 v30, 0x3fb8aa3b, v30
    v_mul_f32 v31, 0x3fb8aa3b, v31
    v_mul_f32 v32, 0x3fb8aa3b, v32
    v_mul_f32 v33, 0x3fb8aa3b, v33
    v_exp_f32 v26, v26
    v_exp_f32 v27, v27
    v_exp_f32 v28, v28
    v_exp_f32 v29, v29
    v_exp_f32 v30, v30
    v_exp_f32 v31, v31
    v_exp_f32 v32, v32
    v_exp_f32 v33, v33
    v_add_f32 v25, v26, v27
    v_add_f32 v25, v25, v28
    v_add_f32 v25, v25, v29
    v_add_f32 v25, v25, v30
    v_add_f32 v25, v25, v31
    v_add_f32 v25, v25, v32
    v_add_f32 v25, v25, v33
    s_nop 1
    v_add_f32_dpp v25, v25, v25 row_ror:8 row_mask:0xf bank_mask:0xf
    s_nop 1
    v_add_f32_dpp v25, v25, v25 row_ror:4 row_mask:0xf bank_mask:0xf
    s_nop 1
    v_add_f32_dpp v25, v25, v25 row_ror:2 row_mask:0xf bank_mask:0xf
    s_nop 1
    v_add_f32_dpp v25, v25, v25 row_ror:1 row_mask:0xf bank_mask:0xf
    s_nop 1
    v_add_f32_dpp v25, v25, v25 row_bcast:15 row_mask:0xa bank_mask:0xf
    s_nop 1
    v_add_f32_dpp v25, v25, v25 row_bcast:31 row_mask:0xc bank_mask:0xf
    s_nop 0
    v_readlane_b32 s34, v25, 63
    v_mov_b32 v26, s33
    s_nop 0
    v_mov_b32 v27, s34
    s_lshl_b32 s33, s3, 3
    v_mov_b32 v28, s33
    v_mov_b32 v30, 0
    v_mov_b32 v31, 1
    s_mov_b64 exec, 1
    ds_write_b64 v28, v[26:27] offset:6144
    ds_add_u32 v30, v31 offset:6220
    s_mov_b64 exec, -1
    v_and_b32 v29, 7, v1
    v_lshlrev_b32 v29, 3, v29
    s_mov_b32 s60, 0x05040100
    s_mov_b32 s61, 0x07060302
    s_waitcnt vmcnt(3)
    buffer_load_dwordx4 v[80:83], v2, s[36:39], s54 offen offset:2048 nt
    v_perm_b32 v88, v108, v104, s60
    v_perm_b32 v89, v116, v112, s60
    v_perm_b32 v90, v124, v120, s60
    v_perm_b32 v91, v132, v128, s60
    v_perm_b32 v92, v108, v104, s61
    v_perm_b32 v93, v116, v112, s61
    v_perm_b32 v94, v124, v120, s61
    v_perm_b32 v95, v132, v128, s61
    v_perm_b32 v96, v109, v105, s60
    v_perm_b32 v97, v117, v113, s60
    v_perm_b32 v98, v125, v121, s60
    v_perm_b32 v99, v133, v129, s60
    v_perm_b32 v100, v109, v105, s61
    v_perm_b32 v101, v117, v113, s61
    v_perm_b32 v102, v125, v121, s61
    v_perm_b32 v103, v133, v129, s61
    v_perm_b32 v8, v110, v106, s60
    v_perm_b32 v9, v118, v114, s60
    v_perm_b32 v10, v126, v122, s60
    v_perm_b32 v11, v134, v130, s60
    v_perm_b32 v20, v110, v106, s61
    v_perm_b32 v21, v118, v114, s61
    v_perm_b32 v22, v126, v122, s61
    v_perm_b32 v23, v134, v130, s61
    v_perm_b32 v24, v111, v107, s60
    v_perm_b32 v25, v119, v115, s60
    v_perm_b32 v26, v127, v123, s60
    v_perm_b32 v27, v135, v131, s60
    v_perm_b32 v32, v111, v107, s61
    v_perm_b32 v33, v119, v115, s61
    v_perm_b32 v34, v127, v123, s61
    v_perm_b32 v35, v135, v131, s61
    s_waitcnt vmcnt(3)
    buffer_load_dwordx4 v[84:87], v2, s[36:39], s54 offen offset:3072 nt
    s_add_u32 s54, s54, 0x8000
    s_and_b32 s54, s54, 0xfffff
    v_perm_b32 v104, v140, v136, s60
    v_perm_b32 v105, v148, v144, s60
    v_perm_b32 v106, v156, v152, s60
    v_perm_b32 v107, v164, v160, s60
    v_perm_b32 v108, v140, v136, s61
    v_perm_b32 v109, v148, v144, s61
    v_perm_b32 v110, v156, v152, s61
    v_perm_b32 v111, v164, v160, s61
    v_perm_b32 v112, v141, v137, s60
    v_perm_b32 v113, v149, v145, s60
    v_perm_b32 v114, v157, v153, s60
    v_perm_b32 v115, v165, v161, s60
    v_perm_b32 v116, v141, v137, s61
    v_perm_b32 v117, v149, v145, s61
    v_perm_b32 v118, v157, v153, s61
    v_perm_b32 v119, v165, v161, s61
    v_perm_b32 v120, v142, v138, s60
    v_perm_b32 v121, v150, v146, s60
    v_perm_b32 v122, v158, v154, s60
    v_perm_b32 v123, v166, v162, s60
    v_perm_b32 v124, v142, v138, s61
    v_perm_b32 v125, v150, v146, s61
    v_perm_b32 v126, v158, v154, s61
    v_perm_b32 v127, v166, v162, s61
    v_perm_b32 v128, v143, v139, s60
    v_perm_b32 v129, v151, v147, s60
    v_perm_b32 v130, v159, v155, s60
    v_perm_b32 v131, v167, v163, s60
    v_perm_b32 v132, v143, v139, s61
    v_perm_b32 v133, v151, v147, s61
    v_perm_b32 v134, v159, v155, s61
    v_perm_b32 v135, v167, v163, s61
    v_mov_b32 v136, v88
    v_mov_b32 v137, v89
    v_mov_b32 v138, v90
    v_mov_b32 v139, v91
    v_mov_b32 v140, v92
    v_mov_b32 v141, v93
    v_mov_b32 v142, v94
    v_mov_b32 v143, v95
    v_mov_b32 v144, v96
    v_mov_b32 v145, v97
    v_mov_b32 v146, v98
    v_mov_b32 v147, v99
    v_mov_b32 v148, v100
    v_mov_b32 v149, v101
    v_mov_b32 v150, v102
    v_mov_b32 v151, v103
    v_mov_b32 v152, v8
    v_mov_b32 v153, v9
    v_mov_b32 v154, v10
    v_mov_b32 v155, v11
    v_mov_b32 v156, v20
    v_mov_b32 v157, v21
    v_mov_b32 v158, v22
    v_mov_b32 v159, v23
    v_mov_b32 v160, v24
    v_mov_b32 v161, v25
    v_mov_b32 v162, v26
    v_mov_b32 v163, v27
    v_mov_b32 v164, v32
    v_mov_b32 v165, v33
    v_mov_b32 v166, v34
    v_mov_b32 v167, v35
    s_waitcnt vmcnt(3)
    buffer_load_dwordx4 v[88:91], v2, s[36:39], s54 offen offset:0 nt
    v_mov_b32 v30, 0
L_lwsm:
    ds_read_b32 v31, v30 offset:6220
    s_waitcnt lgkmcnt(0)
    v_readfirstlane_b32 s33, v31
    s_nop 0
    s_cmp_ge_u32 s33, 8
    s_cbranch_scc1 L_lgsm
    s_sleep 0
    s_branch L_lwsm
L_lgsm:
    s_waitcnt vmcnt(3)
    buffer_load_dwordx4 v[92:95], v2, s[36:39], s54 offen offset:1024 nt
    ds_read_b64 v[26:27], v29 offset:6144
    s_waitcnt lgkmcnt(0)
    v_max_f32_dpp v28, v26, v26 row_ror:4 row_mask:0xf bank_mask:0xf
    s_nop 1
    v_max_f32_dpp v28, v28, v28 row_ror:2 row_mask:0xf bank_mask:0xf
    s_nop 1
    v_max_f32_dpp v28, v28, v28 row_ror:1 row_mask:0xf bank_mask:0xf
    v_sub_f32 v26, v26, v28
    v_sub_f32 v12, v12, v28
    v_sub_f32 v13, v13, v28
    v_sub_f32 v14, v14, v28
    v_sub_f32 v15, v15, v28
    v_sub_f32 v16, v16, v28
    v_sub_f32 v17, v17, v28
    v_sub_f32 v18, v18, v28
    v_sub_f32 v19, v19, v28
    v_mul_f32 v26, 0x3fb8aa3b, v26
    v_mul_f32 v12, 0x3fb8aa3b, v12
    v_mul_f32 v13, 0x3fb8aa3b, v13
    v_mul_f32 v14, 0x3fb8aa3b, v14
    v_mul_f32 v15, 0x3fb8aa3b, v15
    v_mul_f32 v16, 0x3fb8aa3b, v16
    v_mul_f32 v17, 0x3fb8aa3b, v17
    v_mul_f32 v18, 0x3fb8aa3b, v18
    v_mul_f32 v19, 0x3fb8aa3b, v19
    v_exp_f32 v26, v26
    v_exp_f32 v12, v12
    v_exp_f32 v13, v13
    v_exp_f32 v14, v14
    v_exp_f32 v15, v15
    v_exp_f32 v16, v16
    v_exp_f32 v17, v17
    v_exp_f32 v18, v18
    v_exp_f32 v19, v19
    v_mul_f32 v26, v26, v27
    s_nop 1
    v_add_f32_dpp v26, v26, v26 row_ror:4 row_mask:0xf bank_mask:0xf
    s_nop 1
    v_add_f32_dpp v26, v26, v26 row_ror:2 row_mask:0xf bank_mask:0xf
    s_nop 1
    v_add_f32_dpp v26, v26, v26 row_ror:1 row_mask:0xf bank_mask:0xf
    s_waitcnt vmcnt(3)
    buffer_load_dwordx4 v[96:99], v2, s[36:39], s54 offen offset:2048 nt
    v_rcp_f32 v27, v26
    s_nop 0
    v_mul_f32 v28, v16, v27
    v_fma_f32 v29, -v28, v26, v16
    v_fma_f32 v28, v29, v27, v28
    v_cvt_pk_bf16_f32 v30, v28, v28
    ds_write_b32 v38, v30 offset:28544
    v_mul_f32 v28, v17, v27
    v_fma_f32 v29, -v28, v26, v17
    v_fma_f32 v28, v29, v27, v28
    v_cvt_pk_bf16_f32 v31, v28, v28
    ds_write_b32 v38, v31 offset:28608
    v_mul_f32 v28, v18, v27
    v_fma_f32 v29, -v28, v26, v18
    v_fma_f32 v28, v29, v27, v28
    v_cvt_pk_bf16_f32 v30, v28, v28
    ds_write_b32 v38, v30 offset:28672
    v_mul_f32 v28, v19, v27
    v_fma_f32 v29, -v28, v26, v19
    v_fma_f32 v28, v29, v27, v28
    v_cvt_pk_bf16_f32 v31, v28, v28
    ds_write_b32 v38, v31 offset:28736
    v_mul_f32 v28, v12, v27
    v_fma_f32 v29, -v28, v26, v12
    v_fma_f32 v28, v29, v27, v28
    v_cvt_pk_bf16_f32 v30, v28, v28
    ds_write_b32 v38, v30 offset:28800
    v_mul_f32 v28, v13, v27
    v_fma_f32 v29, -v28, v26, v13
    v_fma_f32 v28, v29, v27, v28
    v_cvt_pk_bf16_f32 v31, v28, v28
    ds_write_b32 v38, v31 offset:28864
    v_mul_f32 v28, v14, v27
    v_fma_f32 v29, -v28, v26, v14
    v_fma_f32 v28, v29, v27, v28
    v_cvt_pk_bf16_f32 v30, v28, v28
    ds_write_b32 v38, v30 offset:28928
    v_mul_f32 v28, v15, v27
    v_fma_f32 v29, -v28, v26, v15
    v_fma_f32 v28, v29, v27, v28
    v_cvt_pk_bf16_f32 v31, v28, v28
    ds_write_b32 v38, v31 offset:28992
    v_mov_b32 v20, 0
    v_mov_b32 v21, 0
    v_mov_b32 v22, 0
    v_mov_b32 v23, 0
    s_waitcnt vmcnt(3)
    buffer_load_dwordx4 v[100:103], v2, s[36:39], s54 offen offset:3072 nt
    s_add_u32 s54, s54, 0x8000
    s_and_b32 s54, s54, 0xfffff
    v_mov_b32 v38, 0
L_lwta:
    ds_read_b32 v39, v38 offset:6224
    s_waitcnt lgkmcnt(0)
    v_readfirstlane_b32 s33, v39
    s_nop 0
    s_cmp_ge_u32 s33, 1
    s_cbranch_scc1 L_lgta
    s_sleep 4
    s_branch L_lwta
L_lgta:
    v_bfe_u32 v0, v1, 4, 1
    v_lshlrev_b32 v0, 4, v0
    v_bfe_u32 v0, v39, v0, 16
    v_lshlrev_b32 v38, 3, v1
    v_and_b32 v3, 7, v1
    v_lshrrev_b32 v39, 4, v1
    v_lshlrev_b32 v3, 5, v3
    v_lshl_add_u32 v3, v39, 4, v3
    v_lshrrev_b32 v39, 3, v1
    v_lshlrev_b32 v39, 4, v39
    s_mul_i32 s16, s65, 2304
    s_lshl_b32 s66, s67, 8
    s_add_u32 s16, s16, s66
    s_mov_b32 s56, 0xffff0000
    s_mov_b32 s57, 0xffff0000
    s_mov_b32 s35, 0
    s_memrealtime s[62:63]
    s_mov_b32 s32, 390
    s_mov_b32 s31, 847
L_vloop:
    ds_read_b128 v[8:11], v37 offset:28544
    ds_read_b128 v[12:15], v37 offset:28560
    ds_read_b128 v[16:19], v37 offset:28576
    ds_read_b128 v[32:35], v37 offset:28592
    s_waitcnt lgkmcnt(0)
    s_cmp_lg_u32 s18, 0
    s_cselect_b32 s33, s32, 0
    s_add_u32 s18, s18, s33
    s_sub_u32 s33, s62, s18
    s_cmp_eq_u32 s18, 0
    s_cselect_b32 s33, 0, s33
    s_cmp_lg_u32 s15, 0
    s_cselect_b32 s33, 0, s33
    s_cmp_gt_i32 s33, 40
    s_cselect_b64 vcc, -1, 0
    s_cmp_gt_i32 s33, -40
    s_cselect_b32 s19, 1, 0
    s_mov_b32 s14, s62
    s_cmp_eq_u32 s35, 7
    s_cbranch_scc1 L_npv
    s_cmp_eq_u32 s15, 0
    s_cbranch_scc1 L_npv
    s_cmp_lg_u32 s3, 0
    s_cbranch_scc1 L_npv
    s_lshl2_add_u32 s33, s15, s71
    s_sub_u32 s33, s33, 4
    s_mov_b32 s34, s14
    s_atomic_swap s34, s[26:27], s33
L_npv:
    s_sub_u32 s33, s71, 256
    s_load_dword s96, s[26:27], s33
    s_add_u32 s71, s71, 256
    v_and_b32 v24, v8, v4
    v_and_b32 v25, v8, v5
    v_and_b32 v26, v8, v6
    v_and_b32 v27, v8, v7
    s_cbranch_vccnz L_wb66
    s_cmp_lg_u32 s19, 0
    s_cbranch_scc1 L_wm66
    s_waitcnt vmcnt(1)
L_wm66:
    s_waitcnt vmcnt(2)
L_wb66:
    s_waitcnt vmcnt(3)
    s_cmp_eq_u32 s35, 0
    s_cbranch_scc1 L_vskc0
    buffer_load_dwordx4 v[72:75], v2, s[36:39], s54 offen offset:0 nt
L_vskc0:
    v_mfma_f32_16x16x32_bf16 v[20:23], v[24:27], v[40:43], v[20:23]
    v_and_b32 v28, v9, v4
    v_and_b32 v29, v9, v5
    v_and_b32 v30, v9, v6
    v_and_b32 v31, v9, v7
    s_cbranch_vccnz L_wb67
    s_cmp_lg_u32 s19, 0
    s_cbranch_scc1 L_wm67
    s_waitcnt vmcnt(1)
L_wm67:
    s_waitcnt vmcnt(2)
L_wb67:
    s_waitcnt vmcnt(3)
    s_cmp_eq_u32 s35, 0
    s_cbranch_scc1 L_vskc1
    buffer_load_dwordx4 v[76:79], v2, s[36:39], s54 offen offset:1024 nt
L_vskc1:
    v_mfma_f32_16x16x32_bf16 v[20:23], v[28:31], v[44:47], v[20:23]
    v_and_b32 v24, v10, v4
    v_and_b32 v25, v10, v5
    v_and_b32 v26, v10, v6
    v_and_b32 v27, v10, v7
    s_cbranch_vccnz L_wb68
    s_cmp_lg_u32 s19, 0
    s_cbranch_scc1 L_wm68
    s_waitcnt vmcnt(1)
L_wm68:
    s_waitcnt vmcnt(2)
L_wb68:
    s_waitcnt vmcnt(3)
    s_cmp_eq_u32 s35, 0
    s_cbranch_scc1 L_vskc2
    buffer_load_dwordx4 v[80:83], v2, s[36:39], s54 offen offset:2048 nt
L_vskc2:
    v_mfma_f32_16x16x32_bf16 v[20:23], v[24:27], v[48:51], v[20:23]
    v_and_b32 v28, v11, v4
    v_and_b32 v29, v11, v5
    v_and_b32 v30, v11, v6
    v_and_b32 v31, v11, v7
    s_cbranch_vccnz L_wb69
    s_cmp_lg_u32 s19, 0
    s_cbranch_scc1 L_wm69
    s_waitcnt vmcnt(1)
L_wm69:
    s_waitcnt vmcnt(2)
L_wb69:
    s_waitcnt vmcnt(3)
    s_cmp_eq_u32 s35, 0
    s_cbranch_scc1 L_vskc3
    buffer_load_dwordx4 v[84:87], v2, s[36:39], s54 offen offset:3072 nt
    s_add_u32 s54, s54, 0x8000
    s_and_b32 s54, s54, 0xfffff
L_vskc3:
    v_mfma_f32_16x16x32_bf16 v[20:23], v[28:31], v[52:55], v[20:23]
    v_and_b32 v24, v12, v4
    v_and_b32 v25, v12, v5
    v_and_b32 v26, v12, v6
    v_and_b32 v27, v12, v7
    s_cbranch_vccnz L_wb70
    s_cmp_lg_u32 s19, 0
    s_cbranch_scc1 L_wm70
    s_waitcnt vmcnt(1)
L_wm70:
    s_waitcnt vmcnt(2)
L_wb70:
    s_waitcnt vmcnt(3)
    s_cmp_eq_u32 s35, 0
    s_cbranch_scc1 L_vskc4
    buffer_load_dwordx4 v[88:91], v2, s[36:39], s54 offen offset:0 nt
L_vskc4:
    v_mfma_f32_16x16x32_bf16 v[20:23], v[24:27], v[56:59], v[20:23]
    v_and_b32 v28, v13, v4
    v_and_b32 v29, v13, v5
    v_and_b32 v30, v13, v6
    v_and_b32 v31, v13, v7
    s_cbranch_vccnz L_wb71
    s_cmp_lg_u32 s19, 0
    s_cbranch_scc1 L_wm71
    s_waitcnt vmcnt(1)
L_wm71:
    s_waitcnt vmcnt(2)
L_wb71:
    s_waitcnt vmcnt(3)
    s_cmp_eq_u32 s35, 0
    s_cbranch_scc1 L_vskc5
    buffer_load_dwordx4 v[92:95], v2, s[36:39], s54 offen offset:1024 nt
L_vskc5:
    v_mfma_f32_16x16x32_bf16 v[20:23], v[28:31], v[60:63], v[20:23]
    v_and_b32 v24, v14, v4
    v_and_b32 v25, v14, v5
    v_and_b32 v26, v14, v6
    v_and_b32 v27, v14, v7
    s_cbranch_vccnz L_wb72
    s_cmp_lg_u32 s19, 0
    s_cbranch_scc1 L_wm72
    s_waitcnt vmcnt(1)
L_wm72:
    s_waitcnt vmcnt(2)
L_wb72:
    s_waitcnt vmcnt(3)
    s_cmp_eq_u32 s35, 0
    s_cbranch_scc1 L_vskc6
    buffer_load_dwordx4 v[96:99], v2, s[36:39], s54 offen offset:2048 nt
L_vskc6:
    v_mfma_f32_16x16x32_bf16 v[20:23], v[24:27], v[64:67], v[20:23]
    v_and_b32 v28, v15, v4
    v_and_b32 v29, v15, v5
    v_and_b32 v30, v15, v6
    v_and_b32 v31, v15, v7
    s_cbranch_vccnz L_wb73
    s_cmp_lg_u32 s19, 0
    s_cbranch_scc1 L_wm73
    s_waitcnt vmcnt(1)
L_wm73:
    s_waitcnt vmcnt(2)
L_wb73:
    s_waitcnt vmcnt(3)
    s_cmp_eq_u32 s35, 0
    s_cbranch_scc1 L_vskc7
    buffer_load_dwordx4 v[100:103], v2, s[36:39], s54 offen offset:3072 nt
    s_add_u32 s54, s54, 0x8000
    s_and_b32 s54, s54, 0xfffff
L_vskc7:
    s_memrealtime s[62:63]
    v_mfma_f32_16x16x32_bf16 v[20:23], v[28:31], v[68:71], v[20:23]
    s_waitcnt lgkmcnt(0)
    s_cmp_lg_u32 s18, 0
    s_cselect_b32 s33, 217, 0
    s_add_u32 s18, s18, s33
    s_sub_u32 s34, s96, s17
    s_add_u32 s33, s96, s31
    s_cmp_lt_u32 s34, 0x8000
    s_cselect_b32 s18, s33, s18
    s_sub_u32 s33, s62, s18
    s_cmp_eq_u32 s18, 0
    s_cselect_b32 s33, 0, s33
    s_cmp_lg_u32 s15, 0
    s_cselect_b32 s33, 0, s33
    s_cmp_gt_i32 s33, 40
    s_cselect_b64 vcc, -1, 0
    s_cmp_gt_i32 s33, -40
    s_cselect_b32 s19, 1, 0
    v_and_b32 v24, v16, v4
    v_and_b32 v25, v16, v5
    v_and_b32 v26, v16, v6
    v_and_b32 v27, v16, v7
    s_cbranch_vccnz L_wb75
    s_cmp_lg_u32 s19, 0
    s_cbranch_scc1 L_wm75
    s_waitcnt vmcnt(1)
L_wm75:
    s_waitcnt vmcnt(2)
L_wb75:
    s_waitcnt vmcnt(3)
    s_cmp_eq_u32 s35, 7
    s_cselect_b32 s38, 0, s38
    buffer_load_dwordx4 v[40:43], v2, s[36:39], s54 offen offset:0 nt
    v_mfma_f32_16x16x32_bf16 v[20:23], v[24:27], v[72:75], v[20:23]
    v_and_b32 v28, v17, v4
    v_and_b32 v29, v17, v5
    v_and_b32 v30, v17, v6
    v_and_b32 v31, v17, v7
    s_cbranch_vccnz L_wb76
    s_cmp_lg_u32 s19, 0
    s_cbranch_scc1 L_wm76
    s_waitcnt vmcnt(1)
L_wm76:
    s_waitcnt vmcnt(2)
L_wb76:
    s_waitcnt vmcnt(3)
    buffer_load_dwordx4 v[44:47], v2, s[36:39], s54 offen offset:1024 nt
    v_mfma_f32_16x16x32_bf16 v[20:23], v[28:31], v[76:79], v[20:23]
    v_and_b32 v24, v18, v4
    v_and_b32 v25, v18, v5
    v_and_b32 v26, v18, v6
    v_and_b32 v27, v18, v7
    s_cbranch_vccnz L_wb77
    s_cmp_lg_u32 s19, 0
    s_cbranch_scc1 L_wm77
    s_waitcnt vmcnt(1)
L_wm77:
    s_waitcnt vmcnt(2)
L_wb77:
    s_waitcnt vmcnt(3)
    buffer_load_dwordx4 v[48:51], v2, s[36:39], s54 offen offset:2048 nt
    v_mfma_f32_16x16x32_bf16 v[20:23], v[24:27], v[80:83], v[20:23]
    v_and_b32 v28, v19, v4
    v_and_b32 v29, v19, v5
    v_and_b32 v30, v19, v6
    v_and_b32 v31, v19, v7
    s_cbranch_vccnz L_wb78
    s_cmp_lg_u32 s19, 0
    s_cbranch_scc1 L_wm78
    s_waitcnt vmcnt(1)
L_wm78:
    s_waitcnt vmcnt(2)
L_wb78:
    s_waitcnt vmcnt(3)
    buffer_load_dwordx4 v[52:55], v2, s[36:39], s54 offen offset:3072 nt
    s_add_u32 s54, s54, 0x8000
    s_and_b32 s54, s54, 0xfffff
    v_mfma_f32_16x16x32_bf16 v[20:23], v[28:31], v[84:87], v[20:23]
    v_and_b32 v24, v32, v4
    v_and_b32 v25, v32, v5
    v_and_b32 v26, v32, v6
    v_and_b32 v27, v32, v7
    s_cbranch_vccnz L_wb79
    s_cmp_lg_u32 s19, 0
    s_cbranch_scc1 L_wm79
    s_waitcnt vmcnt(1)
L_wm79:
    s_waitcnt vmcnt(2)
L_wb79:
    s_waitcnt vmcnt(3)
    buffer_load_dwordx4 v[56:59], v2, s[36:39], s54 offen offset:0 nt
    v_mfma_f32_16x16x32_bf16 v[20:23], v[24:27], v[88:91], v[20:23]
    v_and_b32 v28, v33, v4
    v_and_b32 v29, v33, v5
    v_and_b32 v30, v33, v6
    v_and_b32 v31, v33, v7
    s_cbranch_vccnz L_wb80
    s_cmp_lg_u32 s19, 0
    s_cbranch_scc1 L_wm80
    s_waitcnt vmcnt(1)
L_wm80:
    s_waitcnt vmcnt(2)
L_wb80:
    s_waitcnt vmcnt(3)
    buffer_load_dwordx4 v[60:63], v2, s[36:39], s54 offen offset:1024 nt
    v_mfma_f32_16x16x32_bf16 v[20:23], v[28:31], v[92:95], v[20:23]
    v_and_b32 v24, v34, v4
    v_and_b32 v25, v34, v5
    v_and_b32 v26, v34, v6
    v_and_b32 v27, v34, v7
    s_cbranch_vccnz L_wb81
    s_cmp_lg_u32 s19, 0
    s_cbranch_scc1 L_wm81
    s_waitcnt vmcnt(1)
L_wm81:
    s_waitcnt vmcnt(2)
L_wb81:
    s_waitcnt vmcnt(3)
    buffer_load_dwordx4 v[64:67], v2, s[36:39], s54 offen offset:2048 nt
    v_mfma_f32_16x16x32_bf16 v[20:23], v[24:27], v[96:99], v[20:23]
    v_and_b32 v28, v35, v4
    v_and_b32 v29, v35, v5
    v_and_b32 v30, v35, v6
    v_and_b32 v31, v35, v7
    s_cbranch_vccnz L_wb82
    s_cmp_lg_u32 s19, 0
    s_cbranch_scc1 L_wm82
    s_waitcnt vmcnt(1)
L_wm82:
    s_waitcnt vmcnt(2)
L_wb82:
    s_waitcnt vmcnt(3)
    buffer_load_dwordx4 v[68:71], v2, s[36:39], s54 offen offset:3072 nt
    s_add_u32 s54, s54, 0x8000
    s_and_b32 s54, s54, 0xfffff
    s_memrealtime s[62:63]
    v_mfma_f32_16x16x32_bf16 v[20:23], v[28:31], v[100:103], v[20:23]
    v_add_u32 v37, 64, v37
    s_add_u32 s35, s35, 1
    s_mov_b32 s32, 217
    s_mov_b32 s31, 652
    s_cmp_lt_u32 s35, 8
    s_cbranch_scc1 L_vloop
    s_waitcnt lgkmcnt(0)
    s_nop 0
    ds_write_b128 v36, v[20:23] offset:2048
L_tail:
    s_waitcnt lgkmcnt(0)
    s_barrier
    ds_read_b64 v[8:9], v38 offset:2048
    ds_read_b64 v[10:11], v38 offset:2560
    ds_read_b64 v[12:13], v38 offset:3072
    ds_read_b64 v[14:15], v38 offset:3584
    ds_read_b64 v[16:17], v38 offset:4096
    ds_read_b64 v[18:19], v38 offset:4608
    ds_read_b64 v[20:21], v38 offset:5120
    ds_read_b64 v[22:23], v38 offset:5632
    s_waitcnt lgkmcnt(4)
    v_pk_add_f32 v[8:9], v[8:9], v[10:11]
    v_pk_add_f32 v[12:13], v[12:13], v[14:15]
    s_waitcnt lgkmcnt(0)
    v_pk_add_f32 v[16:17], v[16:17], v[18:19]
    v_pk_add_f32 v[20:21], v[20:21], v[22:23]
    v_pk_add_f32 v[8:9], v[8:9], v[12:13]
    v_pk_add_f32 v[16:17], v[16:17], v[20:21]
    v_pk_add_f32 v[8:9], v[8:9], v[16:17]
    v_cvt_pk_bf16_f32 v8, v8, v9
    ds_bpermute_b32 v24, v39, v8 offset:0
    ds_bpermute_b32 v25, v39, v8 offset:4
    ds_bpermute_b32 v26, v39, v8 offset:8
    ds_bpermute_b32 v27, v39, v8 offset:12
    ds_bpermute_b32 v28, v39, v8 offset:128
    ds_bpermute_b32 v29, v39, v8 offset:132
    ds_bpermute_b32 v30, v39, v8 offset:136
    ds_bpermute_b32 v31, v39, v8 offset:140
    v_bfe_u32 v19, v0, 12, 4
    v_bfe_u32 v18, v0, 8, 4
    v_bfe_u32 v17, v0, 4, 4
    v_bfe_u32 v16, v0, 0, 4
    s_waitcnt lgkmcnt(4)
    v_mfma_f32_16x16x32_bf16 v[72:75], v[24:27], v[136:139], 0
    v_mfma_f32_16x16x32_bf16 v[76:79], v[24:27], v[140:143], 0
    v_mfma_f32_16x16x32_bf16 v[80:83], v[24:27], v[144:147], 0
    v_mfma_f32_16x16x32_bf16 v[84:87], v[24:27], v[148:151], 0
    v_mfma_f32_16x16x32_bf16 v[88:91], v[24:27], v[152:155], 0
    v_mfma_f32_16x16x32_bf16 v[92:95], v[24:27], v[156:159], 0
    v_mfma_f32_16x16x32_bf16 v[96:99], v[24:27], v[160:163], 0
    v_mfma_f32_16x16x32_bf16 v[100:103], v[24:27], v[164:167], 0
    s_waitcnt lgkmcnt(0)
    v_mfma_f32_16x16x32_bf16 v[72:75], v[28:31], v[104:107], v[72:75]
    v_mfma_f32_16x16x32_bf16 v[88:91], v[28:31], v[120:123], v[88:91]
    v_mfma_f32_16x16x32_bf16 v[76:79], v[28:31], v[108:111], v[76:79]
    v_mfma_f32_16x16x32_bf16 v[92:95], v[28:31], v[124:127], v[92:95]
    v_mfma_f32_16x16x32_bf16 v[80:83], v[28:31], v[112:115], v[80:83]
    v_mfma_f32_16x16x32_bf16 v[96:99], v[28:31], v[128:131], v[96:99]
    v_mfma_f32_16x16x32_bf16 v[84:87], v[28:31], v[116:119], v[84:87]
    v_mfma_f32_16x16x32_bf16 v[100:103], v[28:31], v[132:135], v[100:103]
    s_nop 1
    v_cndmask_b32 v20, v72, v88, s[56:57]
    s_nop 0
    v_cndmask_b32 v21, v76, v92, s[56:57]
    s_nop 0
    v_cndmask_b32 v22, v80, v96, s[56:57]
    s_nop 0
    v_cndmask_b32 v23, v84, v100, s[56:57]
    v_permlane32_swap_b32 v20, v12
    v_permlane32_swap_b32 v21, v13
    v_permlane32_swap_b32 v22, v14
    v_permlane32_swap_b32 v23, v15
    v_add_f32_dpp v20, v12, v20 row_shl:8 row_mask:0xf bank_mask:0x3
    v_add_f32_dpp v21, v13, v21 row_shl:8 row_mask:0xf bank_mask:0x3
    v_add_f32_dpp v22, v14, v22 row_shl:8 row_mask:0xf bank_mask:0x3
    v_add_f32_dpp v23, v15, v23 row_shl:8 row_mask:0xf bank_mask:0x3
    v_bfi_b32 v20, 15, v16, v20
    v_bfi_b32 v21, 15, v17, v21
    v_bfi_b32 v22, 15, v18, v22
    v_bfi_b32 v23, 15, v19, v23
    s_mov_b64 exec, 0x00ff00ff
    buffer_store_dwordx4 v[20:23], v3, s[48:51], s16 offen sc1
    s_mov_b64 exec, -1
    s_lshl2_add_u32 s33, s28, 3
    s_cmp_lg_u32 s29, s33
    s_cbranch_scc1 L_fin
    v_lshrrev_b32 v8, 4, v1
    v_and_b32 v9, 15, v1
    v_mul_u32_u24 v8, 2304, v8
    v_lshl_add_u32 v8, v9, 4, v8
    s_mul_i32 s33, s28, 73728
    s_add_u32 s33, s33, s66
    v_lshrrev_b32 v13, 4, v1
    v_bfrev_b32 v13, v13
    v_lshrrev_b32 v13, 30, v13
    v_and_b32 v12, 15, v1
    v_lshl_add_u32 v12, v12, 2, v13
    v_lshlrev_b32 v13, 2, v12
    v_lshlrev_b32 v12, 1, v12
    s_lshl_b32 s32, s67, 7
    buffer_load_ushort v3, v12, s[40:43], s32 offen
    s_mov_b32 s34, s33
    buffer_load_dwordx4 v[40:43], v8, s[48:51], s34 offen sc1
    s_add_u32 s34, s34, 9216
    buffer_load_dwordx4 v[44:47], v8, s[48:51], s34 offen sc1
    s_add_u32 s34, s34, 9216
    buffer_load_dwordx4 v[48:51], v8, s[48:51], s34 offen sc1
    s_add_u32 s34, s34, 9216
    buffer_load_dwordx4 v[52:55], v8, s[48:51], s34 offen sc1
    s_add_u32 s34, s34, 9216
    buffer_load_dwordx4 v[56:59], v8, s[48:51], s34 offen sc1
    s_add_u32 s34, s34, 9216
    buffer_load_dwordx4 v[60:63], v8, s[48:51], s34 offen sc1
    s_add_u32 s34, s34, 9216
    buffer_load_dwordx4 v[64:67], v8, s[48:51], s34 offen sc1
    s_add_u32 s34, s34, 9216
    buffer_load_dwordx4 v[68:71], v8, s[48:51], s34 offen sc1
    v_add_u32 v13, s66, v13
    ds_read_b32 v14, v13 offset:6272
    v_mov_b32 v10, 0
    ds_read_b32 v15, v10 offset:6224
    s_mul_i32 s31, s28, 1152
    s_add_u32 s44, s22, s31
    s_addc_u32 s45, s23, 0
    s_mov_b32 s46, 0x488
    s_mov_b32 s47, 0x20000
    s_mov_b32 s35, 0
    s_waitcnt lgkmcnt(0)
    v_bfe_u32 v13, v1, 0, 1
    v_lshlrev_b32 v13, 4, v13
    v_bfe_u32 v13, v15, v13, 16
    v_bfe_u32 v19, v13, 12, 4
    v_bfe_u32 v18, v13, 8, 4
    v_bfe_u32 v17, v13, 4, 4
    v_bfe_u32 v16, v13, 0, 4
L_poll:
    s_waitcnt vmcnt(0)
    v_bitop3_b32 v24, v40, v44, v16 bitop3:0x7e
    v_bitop3_b32 v25, v48, v52, v16 bitop3:0x7e
    v_bitop3_b32 v26, v56, v60, v16 bitop3:0x7e
    v_bitop3_b32 v27, v64, v68, v16 bitop3:0x7e
    v_bitop3_b32 v28, v41, v45, v17 bitop3:0x7e
    v_bitop3_b32 v29, v49, v53, v17 bitop3:0x7e
    v_bitop3_b32 v30, v57, v61, v17 bitop3:0x7e
    v_bitop3_b32 v31, v65, v69, v17 bitop3:0x7e
    v_bitop3_b32 v32, v42, v46, v18 bitop3:0x7e
    v_bitop3_b32 v33, v50, v54, v18 bitop3:0x7e
    v_bitop3_b32 v34, v58, v62, v18 bitop3:0x7e
    v_bitop3_b32 v35, v66, v70, v18 bitop3:0x7e
    v_bitop3_b32 v36, v43, v47, v19 bitop3:0x7e
    v_bitop3_b32 v37, v51, v55, v19 bitop3:0x7e
    v_bitop3_b32 v38, v59, v63, v19 bitop3:0x7e
    v_bitop3_b32 v39, v67, v71, v19 bitop3:0x7e
    v_or3_b32 v24, v24, v28, v32
    v_or3_b32 v25, v25, v29, v33
    v_or3_b32 v26, v26, v30, v34
    v_or3_b32 v27, v27, v31, v35
    v_or_b32 v24, v24, v36
    v_or_b32 v25, v25, v37
    v_or_b32 v26, v26, v38
    v_or_b32 v27, v27, v39
    v_or3_b32 v28, v24, v25, v26
    v_or_b32 v28, v28, v27
    v_and_b32 v28, 15, v28
    v_cmp_ne_u32 vcc, 0, v28
    s_cbranch_vccz L_got0
    s_sleep 4
    v_and_b32 v28, 15, v24
    v_cmp_ne_u32 vcc, 0, v28
    s_add_u32 s34, s33, 0
    s_cbranch_vccz L_sk00
    buffer_load_dwordx4 v[40:43], v8, s[48:51], s34 offen sc1
    s_add_u32 s34, s34, 9216
    buffer_load_dwordx4 v[44:47], v8, s[48:51], s34 offen sc1
L_sk00:
    v_and_b32 v28, 15, v25
    v_cmp_ne_u32 vcc, 0, v28
    s_add_u32 s34, s33, 18432
    s_cbranch_vccz L_sk01
    buffer_load_dwordx4 v[48:51], v8, s[48:51], s34 offen sc1
    s_add_u32 s34, s34, 9216
    buffer_load_dwordx4 v[52:55], v8, s[48:51], s34 offen sc1
L_sk01:
    v_and_b32 v28, 15, v26
    v_cmp_ne_u32 vcc, 0, v28
    s_add_u32 s34, s33, 36864
    s_cbranch_vccz L_sk02
    buffer_load_dwordx4 v[56:59], v8, s[48:51], s34 offen sc1
    s_add_u32 s34, s34, 9216
    buffer_load_dwordx4 v[60:63], v8, s[48:51], s34 offen sc1
L_sk02:
    v_and_b32 v28, 15, v27
    v_cmp_ne_u32 vcc, 0, v28
    s_add_u32 s34, s33, 55296
    s_cbranch_vccz L_sk03
    buffer_load_dwordx4 v[64:67], v8, s[48:51], s34 offen sc1
    s_add_u32 s34, s34, 9216
    buffer_load_dwordx4 v[68:71], v8, s[48:51], s34 offen sc1
L_sk03:
    s_add_u32 s35, s35, 1
    s_cmp_lt_u32 s35, 0x100000
    s_cbranch_scc1 L_poll
    s_branch L_fin
L_got0:
    v_and_b32 v40, -16, v40
    v_and_b32 v41, -16, v41
    v_and_b32 v42, -16, v42
    v_and_b32 v43, -16, v43
    v_and_b32 v44, -16, v44
    v_and_b32 v45, -16, v45
    v_and_b32 v46, -16, v46
    v_and_b32 v47, -16, v47
    v_and_b32 v48, -16, v48
    v_and_b32 v49, -16, v49
    v_and_b32 v50, -16, v50
    v_and_b32 v51, -16, v51
    v_and_b32 v52, -16, v52
    v_and_b32 v53, -16, v53
    v_and_b32 v54, -16, v54
    v_and_b32 v55, -16, v55
    v_and_b32 v56, -16, v56
    v_and_b32 v57, -16, v57
    v_and_b32 v58, -16, v58
    v_and_b32 v59, -16, v59
    v_and_b32 v60, -16, v60
    v_and_b32 v61, -16, v61
    v_and_b32 v62, -16, v62
    v_and_b32 v63, -16, v63
    v_and_b32 v64, -16, v64
    v_and_b32 v65, -16, v65
    v_and_b32 v66, -16, v66
    v_and_b32 v67, -16, v67
    v_and_b32 v68, -16, v68
    v_and_b32 v69, -16, v69
    v_and_b32 v70, -16, v70
    v_and_b32 v71, -16, v71
    v_pk_add_f32 v[40:41], v[40:41], v[56:57]
    v_pk_add_f32 v[42:43], v[42:43], v[58:59]
    v_pk_add_f32 v[44:45], v[44:45], v[60:61]
    v_pk_add_f32 v[46:47], v[46:47], v[62:63]
    v_pk_add_f32 v[48:49], v[48:49], v[64:65]
    v_pk_add_f32 v[50:51], v[50:51], v[66:67]
    v_pk_add_f32 v[52:53], v[52:53], v[68:69]
    v_pk_add_f32 v[54:55], v[54:55], v[70:71]
    v_pk_add_f32 v[40:41], v[40:41], v[48:49]
    v_pk_add_f32 v[42:43], v[42:43], v[50:51]
    v_pk_add_f32 v[44:45], v[44:45], v[52:53]
    v_pk_add_f32 v[46:47], v[46:47], v[54:55]
    v_pk_add_f32 v[24:25], v[40:41], v[44:45]
    v_pk_add_f32 v[26:27], v[42:43], v[46:47]
L_fsum:
    s_nop 0
    v_permlane32_swap_b32 v24, v25
    v_permlane32_swap_b32 v26, v27
    v_add_f32 v24, v24, v25
    v_add_f32 v26, v26, v27
    s_nop 1
    v_permlane16_swap_b32 v24, v26
    v_add_f32 v24, v24, v26
    v_lshlrev_b32 v3, 16, v3
    v_cvt_pk_bf16_f32 v24, v24, v24
    v_and_b32 v24, 0xffff0000, v24
    v_mul_f32 v24, v24, v14
    v_cvt_pk_bf16_f32 v24, v24, v24
    v_and_b32 v24, 0xffff0000, v24
    v_add_f32 v24, v24, v3
    v_cvt_pk_bf16_f32 v24, v24, v24
    buffer_store_short v24, v12, s[44:47], s32 offen
L_fin:
    s_endpgm
L_w:
    s_sub_u32 s68, s3, 8
    v_mov_b32 v8, 0
    v_mov_b32 v9, 0
    v_mov_b32 v10, 0
    v_mov_b32 v11, 0
    ds_write_b128 v8, v[8:11] offset:6208
    ds_write_b128 v8, v[8:11] offset:6224
    v_lshlrev_b32 v0, 1, v1
    v_lshrrev_b32 v21, 4, v1
    v_and_b32 v22, 15, v1
    v_mul_u32_u24 v3, 0x48000, v21
    v_lshl_add_u32 v3, v22, 4, v3
    s_mul_i32 s33, s68, 0x120000
    s_waitcnt lgkmcnt(0)
    s_barrier
    s_or_b32 s34, s2, s68
    s_cmp_lg_u32 s34, 0
    s_cbranch_scc1 L_wni
    s_memrealtime s[62:63]
    s_waitcnt lgkmcnt(0)
    s_or_b32 s34, s62, 1
    v_mov_b32 v10, s34
    s_mov_b64 exec, 1
    global_atomic_cmpswap v8, v[10:11], s[24:25] sc1
    s_mov_b64 exec, -1
    s_nop 1
L_wni:
    s_add_u32 s40, s4, s31
    s_addc_u32 s41, s5, 0
    s_mov_b32 s42, 0x488
    s_mov_b32 s43, 0x20000
    buffer_load_dwordx4 v[8:11], v2, s[40:43], 0 offen nt
    buffer_load_ushort v20, v0, s[40:43], 0 offen offset:1024 nt
    s_add_u32 s44, s10, s32
    s_addc_u32 s45, s11, 0
    s_sub_u32 s46, 0x480000, s32
    s_mov_b32 s47, 0x20000
    s_mov_b32 s55, s33
    v_mov_b32 v2, v3
    v_lshrrev_b32 v23, 1, v1
    v_and_b32 v22, 1, v1
    v_lshlrev_b32 v23, 13, v23
    v_lshl_add_u32 v23, v22, 7, v23
    s_mul_i32 s34, s28, 72
    s_mul_i32 s33, s68, 18
    s_add_u32 s34, s34, s33
    s_lshl_b32 s34, s34, 13
    s_mov_b32 exec_hi, 15
    buffer_load_dword v71, v23, s[44:47], s34 offen
    s_mov_b32 exec_hi, -1
    s_mov_b32 s58, 0
    s_add_u32 s56, s70, 0
    s_and_b32 s56, s56, 31
    v_and_b32 v69, 7, v1
    v_lshrrev_b32 v70, 3, v1
    s_cmp_eq_u32 s68, 0
    s_cbranch_scc1 L_ns0
    s_cmp_ge_u32 s56, 18
    s_cbranch_scc1 L_ns2
    s_sub_u32 s57, s56, 9
    s_cmp_lt_u32 s56, 9
    s_cselect_b32 s57, s56, s57
    s_cselect_b32 s33, s16, s18
    s_cselect_b32 s34, s17, s19
    s_mul_i32 s31, s69, 9
    s_add_u32 s57, s57, s31
    s_lshl_b32 s31, s57, 7
    s_add_u32 s36, s33, s31
    s_addc_u32 s37, s34, 0
    s_sub_u32 s38, 0x510000, s31
    s_mov_b32 s52, 9216
    s_mov_b32 s53, 525312
    s_mov_b32 s32, 73728
    s_branch L_nsj
L_ns2:
    s_sub_u32 s57, s56, 18
    s_mul_i32 s31, s69, 663552
    s_lshl_b32 s32, s57, 7
    s_add_u32 s31, s31, s32
    s_cmp_ge_u32 s56, 27
    s_cselect_b32 s31, 0, s31
    s_cselect_b32 s32, 0, 0x510000
    s_add_u32 s36, s20, s31
    s_addc_u32 s37, s21, 0
    s_sub_u32 s38, s32, s31
    s_mov_b32 s52, 1152
    s_mov_b32 s53, 65664
    s_mov_b32 s32, 9216
L_nsj:
    s_sub_u32 s33, s68, 1
    s_mul_i32 s33, s33, 192
    s_mul_i32 s54, s33, s52
    s_branch L_nse
L_ns0:
    s_mul_i32 s31, s29, 0x24000
    s_add_u32 s31, s31, 1024
    s_add_u32 s36, s12, s31
    s_addc_u32 s37, s13, 0
    s_sub_u32 s38, 0x480000, s31
    s_mov_b32 s52, 1152
    s_mov_b32 s53, 65664
    s_mov_b32 s32, 9216
    s_mov_b32 s54, 0
L_nse:
    s_mov_b32 s39, 0x20000
    v_mul_lo_u32 v68, v70, s32
    v_lshl_add_u32 v68, v69, 4, v68
    s_mov_b32 s48, s26
    s_mov_b32 s49, s27
    s_mov_b32 s50, 0x800000
    s_mov_b32 s51, 0x20000
    v_and_b32 v22, 1, v1
    v_lshlrev_b32 v22, 4, v22
    v_mov_b32 v23, 0xffff
    v_lshlrev_b32 v22, v22, v23
    v_bfe_u32 v23, v1, 1, 2
    v_cmp_eq_u32 vcc, 0, v23
    s_nop 1
    v_cndmask_b32 v4, 0, v22, vcc
    v_cmp_eq_u32 vcc, 1, v23
    s_nop 1
    v_cndmask_b32 v5, 0, v22, vcc
    v_cmp_eq_u32 vcc, 2, v23
    s_nop 1
    v_cndmask_b32 v6, 0, v22, vcc
    v_cmp_eq_u32 vcc, 3, v23
    s_nop 1
    v_cndmask_b32 v7, 0, v22, vcc
    s_mul_i32 s33, s68, 2304
    v_lshl_add_u32 v3, v1, 5, s33
    s_mul_i32 s34, s68, 2880
    v_mul_u32_u24 v0, 144, v21
    v_add_u32 v0, s34, v0
    s_waitcnt vmcnt(1)
    v_lshlrev_b32 v12, 16, v8
    v_and_b32 v13, 0xffff0000, v8
    v_lshlrev_b32 v14, 16, v9
    v_and_b32 v15, 0xffff0000, v9
    v_lshlrev_b32 v16, 16, v10
    v_and_b32 v17, 0xffff0000, v10
    v_lshlrev_b32 v18, 16, v11
    v_and_b32 v19, 0xffff0000, v11
    v_lshlrev_b32 v20, 16, v20
    v_add_f32 v8, v12, v13
    v_add_f32 v8, v8, v14
    v_add_f32 v8, v8, v15
    v_add_f32 v8, v8, v16
    v_add_f32 v8, v8, v17
    v_add_f32 v8, v8, v18
    v_add_f32 v8, v8, v19
    v_add_f32 v8, v8, v20
    s_nop 1
    v_add_f32_dpp v8, v8, v8 row_ror:8 row_mask:0xf bank_mask:0xf
    s_nop 1
    v_add_f32_dpp v8, v8, v8 row_ror:4 row_mask:0xf bank_mask:0xf
    s_nop 1
    v_add_f32_dpp v8, v8, v8 row_ror:2 row_mask:0xf bank_mask:0xf
    s_nop 1
    v_add_f32_dpp v8, v8, v8 row_ror:1 row_mask:0xf bank_mask:0xf
    s_nop 1
    v_add_f32_dpp v8, v8, v8 row_bcast:15 row_mask:0xa bank_mask:0xf
    s_nop 1
    v_add_f32_dpp v8, v8, v8 row_bcast:31 row_mask:0xc bank_mask:0xf
    s_nop 0
    v_readlane_b32 s34, v8, 63
    v_mov_b32 v9, 0x3ae38e39
    s_nop 0
    v_mul_f32 v9, s34, v9
    v_sub_f32 v10, v12, v9
    v_mul_f32 v8, v10, v10
    v_sub_f32 v10, v13, v9
    v_fmac_f32 v8, v10, v10
    v_sub_f32 v10, v14, v9
    v_fmac_f32 v8, v10, v10
    v_sub_f32 v10, v15, v9
    v_fmac_f32 v8, v10, v10
    v_sub_f32 v10, v16, v9
    v_fmac_f32 v8, v10, v10
    v_sub_f32 v10, v17, v9
    v_fmac_f32 v8, v10, v10
    v_sub_f32 v10, v18, v9
    v_fmac_f32 v8, v10, v10
    v_sub_f32 v10, v19, v9
    v_fmac_f32 v8, v10, v10
    v_sub_f32 v10, v20, v9
    v_fmac_f32 v8, v10, v10
    s_nop 1
    v_add_f32_dpp v8, v8, v8 row_ror:8 row_mask:0xf bank_mask:0xf
    s_nop 1
    v_add_f32_dpp v8, v8, v8 row_ror:4 row_mask:0xf bank_mask:0xf
    s_nop 1
    v_add_f32_dpp v8, v8, v8 row_ror:2 row_mask:0xf bank_mask:0xf
    s_nop 1
    v_add_f32_dpp v8, v8, v8 row_ror:1 row_mask:0xf bank_mask:0xf
    s_nop 1
    v_add_f32_dpp v8, v8, v8 row_bcast:15 row_mask:0xa bank_mask:0xf
    s_nop 1
    v_add_f32_dpp v8, v8, v8 row_bcast:31 row_mask:0xc bank_mask:0xf
    s_nop 0
    v_readlane_b32 s34, v8, 63
    v_mov_b32 v10, 0x3ae38e39
    s_nop 0
    v_mul_f32 v10, s34, v10
    v_cvt_pk_bf16_f32 v8, v9, v9
    v_and_b32 v8, 0xffff0000, v8
    v_cvt_pk_bf16_f32 v11, v10, v10
    v_and_b32 v11, 0xffff0000, v11
    v_add_f32 v11, 0x3727c5ac, v11
    v_cvt_pk_bf16_f32 v11, v11, v11
    v_and_b32 v11, 0xffff0000, v11
    v_sqrt_f32 v11, v11
    s_nop 0
    v_cvt_pk_bf16_f32 v11, v11, v11
    v_and_b32 v11, 0xffff0000, v11
    v_rcp_f32 v21, v11
    v_sub_f32 v12, v12, v8
    v_sub_f32 v13, v13, v8
    v_sub_f32 v14, v14, v8
    v_sub_f32 v15, v15, v8
    v_sub_f32 v16, v16, v8
    v_sub_f32 v17, v17, v8
    v_sub_f32 v18, v18, v8
    v_sub_f32 v19, v19, v8
    v_sub_f32 v20, v20, v8
    v_cvt_pk_bf16_f32 v12, v12, v12
    v_and_b32 v12, 0xffff0000, v12
    v_cvt_pk_bf16_f32 v13, v13, v13
    v_and_b32 v13, 0xffff0000, v13
    v_cvt_pk_bf16_f32 v14, v14, v14
    v_and_b32 v14, 0xffff0000, v14
    v_cvt_pk_bf16_f32 v15, v15, v15
    v_and_b32 v15, 0xffff0000, v15
    v_cvt_pk_bf16_f32 v16, v16, v16
    v_and_b32 v16, 0xffff0000, v16
    v_cvt_pk_bf16_f32 v17, v17, v17
    v_and_b32 v17, 0xffff0000, v17
    v_cvt_pk_bf16_f32 v18, v18, v18
    v_and_b32 v18, 0xffff0000, v18
    v_cvt_pk_bf16_f32 v19, v19, v19
    v_and_b32 v19, 0xffff0000, v19
    v_cvt_pk_bf16_f32 v20, v20, v20
    v_and_b32 v20, 0xffff0000, v20
    v_mul_f32 v9, v12, v21
    v_fma_f32 v10, -v9, v11, v12
    v_fma_f32 v9, v10, v21, v9
    v_cvt_pk_bf16_f32 v12, v9, v9
    v_mul_f32 v9, v13, v21
    v_fma_f32 v10, -v9, v11, v13
    v_fma_f32 v9, v10, v21, v9
    v_cvt_pk_bf16_f32 v13, v9, v9
    v_mul_f32 v9, v14, v21
    v_fma_f32 v10, -v9, v11, v14
    v_fma_f32 v9, v10, v21, v9
    v_cvt_pk_bf16_f32 v14, v9, v9
    v_mul_f32 v9, v15, v21
    v_fma_f32 v10, -v9, v11, v15
    v_fma_f32 v9, v10, v21, v9
    v_cvt_pk_bf16_f32 v15, v9, v9
    v_mul_f32 v9, v16, v21
    v_fma_f32 v10, -v9, v11, v16
    v_fma_f32 v9, v10, v21, v9
    v_cvt_pk_bf16_f32 v16, v9, v9
    v_mul_f32 v9, v17, v21
    v_fma_f32 v10, -v9, v11, v17
    v_fma_f32 v9, v10, v21, v9
    v_cvt_pk_bf16_f32 v17, v9, v9
    v_mul_f32 v9, v18, v21
    v_fma_f32 v10, -v9, v11, v18
    v_fma_f32 v9, v10, v21, v9
    v_cvt_pk_bf16_f32 v18, v9, v9
    v_mul_f32 v9, v19, v21
    v_fma_f32 v10, -v9, v11, v19
    v_fma_f32 v9, v10, v21, v9
    v_cvt_pk_bf16_f32 v19, v9, v9
    v_mul_f32 v9, v20, v21
    v_fma_f32 v10, -v9, v11, v20
    v_fma_f32 v9, v10, v21, v9
    v_cvt_pk_bf16_f32 v20, v9, v9
    ds_write_b128 v3, v[12:15] offset:13184
    ds_write_b128 v3, v[16:19] offset:13200
    v_lshlrev_b32 v22, 2, v1
    v_add_u32 v22, s33, v22
    ds_write_b32 v22, v20 offset:15232
    ds_read_b128 v[12:15], v0 offset:13184
    s_waitcnt vmcnt(0)
    buffer_load_dwordx4 v[24:27], v2, s[44:47], s55 offen
    s_add_u32 s55, s55, 0x2000
    buffer_load_dwordx4 v[28:31], v2, s[44:47], s55 offen
    s_add_u32 s55, s55, 0x2000
    buffer_load_dwordx4 v[32:35], v2, s[44:47], s55 offen
    s_add_u32 s55, s55, 0x2000
    buffer_load_dwordx4 v[36:39], v2, s[44:47], s55 offen
    s_add_u32 s55, s55, 0x2000
    buffer_load_dwordx4 v[40:43], v2, s[44:47], s55 offen
    s_add_u32 s55, s55, 0x2000
    buffer_load_dwordx4 v[44:47], v2, s[44:47], s55 offen
    s_add_u32 s55, s55, 0x2000
    buffer_load_dwordx4 v[48:51], v2, s[44:47], s55 offen
    s_add_u32 s55, s55, 0x2000
    buffer_load_dwordx4 v[52:55], v2, s[44:47], s55 offen
    s_add_u32 s55, s55, 0x2000
    buffer_load_dwordx4 v[56:59], v2, s[44:47], s55 offen
    s_add_u32 s55, s55, 0x2000
    s_waitcnt lgkmcnt(0)
    ds_read_b128 v[16:19], v0 offset:13200
    v_and_b32 v20, v12, v4
    v_and_b32 v21, v12, v5
    v_and_b32 v22, v12, v6
    v_and_b32 v23, v12, v7
    s_waitcnt vmcnt(8)
    s_nop 0
    v_mfma_f32_16x16x32_bf16 v[8:11], v[20:23], v[24:27], 0
    buffer_load_dwordx4 v[60:63], v2, s[44:47], s55 offen
    s_add_u32 s55, s55, 0x2000
    v_and_b32 v20, v13, v4
    v_and_b32 v21, v13, v5
    v_and_b32 v22, v13, v6
    v_and_b32 v23, v13, v7
    s_waitcnt vmcnt(8)
    s_nop 0
    v_mfma_f32_16x16x32_bf16 v[8:11], v[20:23], v[28:31], v[8:11]
    buffer_load_dwordx4 v[24:27], v2, s[44:47], s55 offen
    s_add_u32 s55, s55, 0x2000
    v_and_b32 v20, v14, v4
    v_and_b32 v21, v14, v5
    v_and_b32 v22, v14, v6
    v_and_b32 v23, v14, v7
    s_waitcnt vmcnt(8)
    s_nop 0
    v_mfma_f32_16x16x32_bf16 v[8:11], v[20:23], v[32:35], v[8:11]
    buffer_load_dwordx4 v[28:31], v2, s[44:47], s55 offen
    s_add_u32 s55, s55, 0x2000
    v_and_b32 v20, v15, v4
    v_and_b32 v21, v15, v5
    v_and_b32 v22, v15, v6
    v_and_b32 v23, v15, v7
    s_waitcnt vmcnt(8)
    s_nop 0
    v_mfma_f32_16x16x32_bf16 v[8:11], v[20:23], v[36:39], v[8:11]
    buffer_load_dwordx4 v[32:35], v2, s[44:47], s55 offen
    s_add_u32 s55, s55, 0x2000
    s_waitcnt lgkmcnt(0)
    ds_read_b128 v[12:15], v0 offset:13216
    v_and_b32 v20, v16, v4
    v_and_b32 v21, v16, v5
    v_and_b32 v22, v16, v6
    v_and_b32 v23, v16, v7
    s_waitcnt vmcnt(8)
    s_nop 0
    v_mfma_f32_16x16x32_bf16 v[8:11], v[20:23], v[40:43], v[8:11]
    buffer_load_dwordx4 v[36:39], v2, s[44:47], s55 offen
    s_add_u32 s55, s55, 0x2000
    v_and_b32 v20, v17, v4
    v_and_b32 v21, v17, v5
    v_and_b32 v22, v17, v6
    v_and_b32 v23, v17, v7
    s_waitcnt vmcnt(8)
    s_nop 0
    v_mfma_f32_16x16x32_bf16 v[8:11], v[20:23], v[44:47], v[8:11]
    buffer_load_dwordx4 v[40:43], v2, s[44:47], s55 offen
    s_add_u32 s55, s55, 0x2000
    v_and_b32 v20, v18, v4
    v_and_b32 v21, v18, v5
    v_and_b32 v22, v18, v6
    v_and_b32 v23, v18, v7
    s_waitcnt vmcnt(8)
    s_nop 0
    v_mfma_f32_16x16x32_bf16 v[8:11], v[20:23], v[48:51], v[8:11]
    buffer_load_dwordx4 v[44:47], v2, s[44:47], s55 offen
    s_add_u32 s55, s55, 0x2000
    v_and_b32 v20, v19, v4
    v_and_b32 v21, v19, v5
    v_and_b32 v22, v19, v6
    v_and_b32 v23, v19, v7
    s_waitcnt vmcnt(8)
    s_nop 0
    v_mfma_f32_16x16x32_bf16 v[8:11], v[20:23], v[52:55], v[8:11]
    buffer_load_dwordx4 v[48:51], v2, s[44:47], s55 offen
    s_add_u32 s55, s55, 0x2000
    s_waitcnt lgkmcnt(0)
    ds_read_b128 v[16:19], v0 offset:13232
    v_and_b32 v20, v12, v4
    v_and_b32 v21, v12, v5
    v_and_b32 v22, v12, v6
    v_and_b32 v23, v12, v7
    s_waitcnt vmcnt(8)
    s_nop 0
    v_mfma_f32_16x16x32_bf16 v[8:11], v[20:23], v[56:59], v[8:11]
    buffer_load_dwordx4 v[52:55], v2, s[44:47], s55 offen
    s_add_u32 s55, s55, 0x2000
    v_and_b32 v20, v13, v4
    v_and_b32 v21, v13, v5
    v_and_b32 v22, v13, v6
    v_and_b32 v23, v13, v7
    s_waitcnt vmcnt(8)
    s_nop 0
    v_mfma_f32_16x16x32_bf16 v[8:11], v[20:23], v[60:63], v[8:11]
    buffer_load_dwordx4 v[56:59], v2, s[44:47], s55 offen
    s_add_u32 s55, s55, 0x2000
    v_and_b32 v20, v14, v4
    v_and_b32 v21, v14, v5
    v_and_b32 v22, v14, v6
    v_and_b32 v23, v14, v7
    s_waitcnt vmcnt(8)
    s_nop 0
    v_mfma_f32_16x16x32_bf16 v[8:11], v[20:23], v[24:27], v[8:11]
    buffer_load_dwordx4 v[60:63], v2, s[44:47], s55 offen
    s_add_u32 s55, s55, 0x2000
    v_and_b32 v20, v15, v4
    v_and_b32 v21, v15, v5
    v_and_b32 v22, v15, v6
    v_and_b32 v23, v15, v7
    s_waitcnt vmcnt(8)
    s_nop 0
    v_mfma_f32_16x16x32_bf16 v[8:11], v[20:23], v[28:31], v[8:11]
    buffer_load_dwordx4 v[24:27], v2, s[44:47], s55 offen
    s_add_u32 s55, s55, 0x2000
    s_waitcnt lgkmcnt(0)
    ds_read_b128 v[12:15], v0 offset:13248
    v_and_b32 v20, v16, v4
    v_and_b32 v21, v16, v5
    v_and_b32 v22, v16, v6
    v_and_b32 v23, v16, v7
    s_waitcnt vmcnt(8)
    s_nop 0
    v_mfma_f32_16x16x32_bf16 v[8:11], v[20:23], v[32:35], v[8:11]
    buffer_load_dwordx4 v[28:31], v2, s[44:47], s55 offen
    s_add_u32 s55, s55, 0x2000
    v_and_b32 v20, v17, v4
    v_and_b32 v21, v17, v5
    v_and_b32 v22, v17, v6
    v_and_b32 v23, v17, v7
    s_waitcnt vmcnt(8)
    s_nop 0
    v_mfma_f32_16x16x32_bf16 v[8:11], v[20:23], v[36:39], v[8:11]
    buffer_load_dwordx4 v[32:35], v2, s[44:47], s55 offen
    s_add_u32 s55, s55, 0x2000
    v_and_b32 v20, v18, v4
    v_and_b32 v21, v18, v5
    v_and_b32 v22, v18, v6
    v_and_b32 v23, v18, v7
    s_waitcnt vmcnt(8)
    s_nop 0
    v_mfma_f32_16x16x32_bf16 v[8:11], v[20:23], v[40:43], v[8:11]
    buffer_load_dwordx4 v[36:39], v2, s[44:47], s55 offen
    s_add_u32 s55, s55, 0x2000
    v_and_b32 v20, v19, v4
    v_and_b32 v21, v19, v5
    v_and_b32 v22, v19, v6
    v_and_b32 v23, v19, v7
    s_waitcnt vmcnt(8)
    s_nop 0
    v_mfma_f32_16x16x32_bf16 v[8:11], v[20:23], v[44:47], v[8:11]
    buffer_load_dwordx4 v[40:43], v2, s[44:47], s55 offen
    s_add_u32 s55, s55, 0x2000
    s_waitcnt lgkmcnt(0)
    ds_read_b128 v[16:19], v0 offset:13264
    v_and_b32 v20, v12, v4
    v_and_b32 v21, v12, v5
    v_and_b32 v22, v12, v6
    v_and_b32 v23, v12, v7
    s_waitcnt vmcnt(8)
    s_nop 0
    v_mfma_f32_16x16x32_bf16 v[8:11], v[20:23], v[48:51], v[8:11]
    buffer_load_dwordx4 v[44:47], v2, s[44:47], s55 offen
    s_add_u32 s55, s55, 0x2000
    v_and_b32 v20, v13, v4
    v_and_b32 v21, v13, v5
    v_and_b32 v22, v13, v6
    v_and_b32 v23, v13, v7
    s_waitcnt vmcnt(8)
    s_nop 0
    v_mfma_f32_16x16x32_bf16 v[8:11], v[20:23], v[52:55], v[8:11]
    buffer_load_dwordx4 v[48:51], v2, s[44:47], s55 offen
    s_add_u32 s55, s55, 0x2000
    v_and_b32 v20, v14, v4
    v_and_b32 v21, v14, v5
    v_and_b32 v22, v14, v6
    v_and_b32 v23, v14, v7
    s_waitcnt vmcnt(8)
    s_nop 0
    v_mfma_f32_16x16x32_bf16 v[8:11], v[20:23], v[56:59], v[8:11]
    buffer_load_dwordx4 v[52:55], v2, s[44:47], s55 offen
    s_add_u32 s55, s55, 0x2000
    v_and_b32 v20, v15, v4
    v_and_b32 v21, v15, v5
    v_and_b32 v22, v15, v6
    v_and_b32 v23, v15, v7
    s_waitcnt vmcnt(8)
    s_nop 0
    v_mfma_f32_16x16x32_bf16 v[8:11], v[20:23], v[60:63], v[8:11]
    buffer_load_dwordx4 v[56:59], v2, s[44:47], s55 offen
    s_add_u32 s55, s55, 0x2000
    s_waitcnt lgkmcnt(0)
    ds_read_b128 v[12:15], v0 offset:13280
    v_and_b32 v20, v16, v4
    v_and_b32 v21, v16, v5
    v_and_b32 v22, v16, v6
    v_and_b32 v23, v16, v7
    s_waitcnt vmcnt(8)
    s_nop 0
    v_mfma_f32_16x16x32_bf16 v[8:11], v[20:23], v[24:27], v[8:11]
    buffer_load_dwordx4 v[60:63], v2, s[44:47], s55 offen
    s_add_u32 s55, s55, 0x2000
    v_and_b32 v20, v17, v4
    v_and_b32 v21, v17, v5
    v_and_b32 v22, v17, v6
    v_and_b32 v23, v17, v7
    s_waitcnt vmcnt(8)
    s_nop 0
    v_mfma_f32_16x16x32_bf16 v[8:11], v[20:23], v[28:31], v[8:11]
    buffer_load_dwordx4 v[24:27], v2, s[44:47], s55 offen
    s_add_u32 s55, s55, 0x2000
    v_and_b32 v20, v18, v4
    v_and_b32 v21, v18, v5
    v_and_b32 v22, v18, v6
    v_and_b32 v23, v18, v7
    s_waitcnt vmcnt(8)
    s_nop 0
    v_mfma_f32_16x16x32_bf16 v[8:11], v[20:23], v[32:35], v[8:11]
    buffer_load_dwordx4 v[28:31], v2, s[44:47], s55 offen
    s_add_u32 s55, s55, 0x2000
    v_and_b32 v20, v19, v4
    v_and_b32 v21, v19, v5
    v_and_b32 v22, v19, v6
    v_and_b32 v23, v19, v7
    s_waitcnt vmcnt(8)
    s_nop 0
    v_mfma_f32_16x16x32_bf16 v[8:11], v[20:23], v[36:39], v[8:11]
    buffer_load_dwordx4 v[32:35], v2, s[44:47], s55 offen
    s_add_u32 s55, s55, 0x2000
    s_waitcnt lgkmcnt(0)
    ds_read_b128 v[16:19], v0 offset:13296
    v_and_b32 v20, v12, v4
    v_and_b32 v21, v12, v5
    v_and_b32 v22, v12, v6
    v_and_b32 v23, v12, v7
    s_waitcnt vmcnt(8)
    s_nop 0
    v_mfma_f32_16x16x32_bf16 v[8:11], v[20:23], v[40:43], v[8:11]
    buffer_load_dwordx4 v[36:39], v2, s[44:47], s55 offen
    s_add_u32 s55, s55, 0x2000
    v_and_b32 v20, v13, v4
    v_and_b32 v21, v13, v5
    v_and_b32 v22, v13, v6
    v_and_b32 v23, v13, v7
    s_waitcnt vmcnt(8)
    s_nop 0
    v_mfma_f32_16x16x32_bf16 v[8:11], v[20:23], v[44:47], v[8:11]
    buffer_load_dwordx4 v[40:43], v2, s[44:47], s55 offen
    s_add_u32 s55, s55, 0x2000
    v_and_b32 v20, v14, v4
    v_and_b32 v21, v14, v5
    v_and_b32 v22, v14, v6
    v_and_b32 v23, v14, v7
    s_waitcnt vmcnt(8)
    s_nop 0
    v_mfma_f32_16x16x32_bf16 v[8:11], v[20:23], v[48:51], v[8:11]
    buffer_load_dwordx4 v[44:47], v2, s[44:47], s55 offen
    v_and_b32 v20, v15, v4
    v_and_b32 v21, v15, v5
    v_and_b32 v22, v15, v6
    v_and_b32 v23, v15, v7
    s_waitcnt vmcnt(8)
    s_nop 0
    v_mfma_f32_16x16x32_bf16 v[8:11], v[20:23], v[52:55], v[8:11]
    buffer_load_dwordx4 v[104:107], v68, s[36:39], s54 offen
    s_add_u32 s54, s54, s52
    s_waitcnt lgkmcnt(0)
    ds_read_b128 v[12:15], v0 offset:13312
    v_and_b32 v20, v16, v4
    v_and_b32 v21, v16, v5
    v_and_b32 v22, v16, v6
    v_and_b32 v23, v16, v7
    s_waitcnt vmcnt(8)
    s_nop 0
    v_mfma_f32_16x16x32_bf16 v[8:11], v[20:23], v[56:59], v[8:11]
    buffer_load_dwordx4 v[108:111], v68, s[36:39], s54 offen
    s_add_u32 s54, s54, s52
    v_and_b32 v20, v17, v4
    v_and_b32 v21, v17, v5
    v_and_b32 v22, v17, v6
    v_and_b32 v23, v17, v7
    s_waitcnt vmcnt(8)
    s_nop 0
    v_mfma_f32_16x16x32_bf16 v[8:11], v[20:23], v[60:63], v[8:11]
    buffer_load_dwordx4 v[112:115], v68, s[36:39], s54 offen
    s_add_u32 s54, s54, s52
    v_and_b32 v20, v18, v4
    v_and_b32 v21, v18, v5
    v_and_b32 v22, v18, v6
    v_and_b32 v23, v18, v7
    s_waitcnt vmcnt(8)
    s_nop 0
    v_mfma_f32_16x16x32_bf16 v[8:11], v[20:23], v[24:27], v[8:11]
    buffer_load_dwordx4 v[116:119], v68, s[36:39], s54 offen
    s_add_u32 s54, s54, s52
    v_and_b32 v20, v19, v4
    v_and_b32 v21, v19, v5
    v_and_b32 v22, v19, v6
    v_and_b32 v23, v19, v7
    s_waitcnt vmcnt(8)
    s_nop 0
    v_mfma_f32_16x16x32_bf16 v[8:11], v[20:23], v[28:31], v[8:11]
    buffer_load_dwordx4 v[120:123], v68, s[36:39], s54 offen
    s_add_u32 s54, s54, s52
    s_waitcnt lgkmcnt(0)
    v_and_b32 v20, v12, v4
    v_and_b32 v21, v12, v5
    v_and_b32 v22, v12, v6
    v_and_b32 v23, v12, v7
    s_waitcnt vmcnt(8)
    s_nop 0
    v_mfma_f32_16x16x32_bf16 v[8:11], v[20:23], v[32:35], v[8:11]
    buffer_load_dwordx4 v[124:127], v68, s[36:39], s54 offen
    s_add_u32 s54, s54, s52
    v_and_b32 v20, v13, v4
    v_and_b32 v21, v13, v5
    v_and_b32 v22, v13, v6
    v_and_b32 v23, v13, v7
    s_waitcnt vmcnt(8)
    s_nop 0
    v_mfma_f32_16x16x32_bf16 v[8:11], v[20:23], v[36:39], v[8:11]
    buffer_load_dwordx4 v[128:131], v68, s[36:39], s54 offen
    s_add_u32 s54, s54, s52
    v_and_b32 v20, v14, v4
    v_and_b32 v21, v14, v5
    v_and_b32 v22, v14, v6
    v_and_b32 v23, v14, v7
    s_waitcnt vmcnt(8)
    s_nop 0
    v_mfma_f32_16x16x32_bf16 v[8:11], v[20:23], v[40:43], v[8:11]
    buffer_load_dwordx4 v[132:135], v68, s[36:39], s54 offen
    s_add_u32 s54, s54, s53
    v_and_b32 v20, v15, v4
    v_and_b32 v21, v15, v5
    v_and_b32 v22, v15, v6
    v_and_b32 v23, v15, v7
    s_waitcnt vmcnt(8)
    s_nop 0
    v_mfma_f32_16x16x32_bf16 v[8:11], v[20:23], v[44:47], v[8:11]
    v_lshlrev_b32 v2, 4, v1
    v_and_b32 v0, 15, v1
    v_bfe_u32 v3, v1, 4, 1
    v_lshlrev_b32 v0, 5, v0
    v_lshl_add_u32 v0, v3, 4, v0
    s_lshl_b32 s33, s68, 9
    v_add_u32 v0, s33, v0
    s_nop 0
    ds_write_b128 v0, v[8:11] offset:0
    v_mov_b32 v12, 0
    v_mov_b32 v13, 1
    s_mov_b64 exec, 1
    ds_add_rtn_u32 v14, v12, v13 offset:6216
    s_mov_b64 exec, -1
    v_lshlrev_b32 v15, 3, v1
    s_waitcnt lgkmcnt(0)
    v_readfirstlane_b32 s33, v14
    s_nop 0
    s_cmp_lg_u32 s33, 3
    s_cbranch_scc1 L_qnl
    ds_read_b64 v[16:17], v15 offset:0
    ds_read_b64 v[18:19], v15 offset:512
    ds_read_b64 v[20:21], v15 offset:1024
    ds_read_b64 v[22:23], v15 offset:1536
    v_lshlrev_b32 v15, 2, v1
    s_waitcnt lgkmcnt(0)
    v_pk_add_f32 v[16:17], v[16:17], v[18:19]
    v_pk_add_f32 v[20:21], v[20:21], v[22:23]
    v_pk_add_f32 v[16:17], v[16:17], v[20:21]
    v_cvt_pk_bf16_f32 v16, v16, v17
    ds_write_b32 v15, v16 offset:45440
    s_mov_b64 exec, 1
    ds_write_b32 v12, v13 offset:6228
    s_mov_b64 exec, -1
L_qnl:
    s_cmp_eq_u32 s68, 0
    s_cbranch_scc1 L_w0
    s_cmp_ge_u32 s56, 27
    s_cbranch_scc1 L_fin
    s_sub_u32 s68, s68, 1
    s_mov_b32 s60, 0x05040100
    s_mov_b32 s61, 0x07060302
    s_cmp_ge_u32 s56, 18
    s_cbranch_scc1 L_dn
    s_mov_b32 s40, s4
    s_mov_b32 s41, s5
    s_mov_b32 s42, 0x2400
    s_mov_b32 s43, 0x20000
    v_mul_u32_u24 v22, 1152, v69
    v_lshl_add_u32 v22, v70, 4, v22
    buffer_load_dwordx4 v[24:27], v22, s[40:43], 0 offen offset:0
    buffer_load_dwordx4 v[28:31], v22, s[40:43], 0 offen offset:128
    buffer_load_dwordx4 v[32:35], v22, s[40:43], 0 offen offset:256
    buffer_load_dwordx4 v[36:39], v22, s[40:43], 0 offen offset:384
    buffer_load_dwordx4 v[40:43], v22, s[40:43], 0 offen offset:512
    buffer_load_dwordx4 v[44:47], v22, s[40:43], 0 offen offset:640
    buffer_load_dwordx4 v[48:51], v22, s[40:43], 0 offen offset:768
    buffer_load_dwordx4 v[52:55], v22, s[40:43], 0 offen offset:896
    buffer_load_dwordx4 v[56:59], v22, s[40:43], 0 offen offset:1024
    s_mul_i32 s33, s68, 384
    buffer_load_dwordx4 v[8:11], v22, s[40:43], s33 offen offset:0
    buffer_load_dwordx4 v[12:15], v22, s[40:43], s33 offen offset:128
    buffer_load_dwordx4 v[16:19], v22, s[40:43], s33 offen offset:256
    v_mov_b32 v61, 0x3f803f80
    s_waitcnt vmcnt(0)
    buffer_load_dwordx4 v[136:139], v68, s[36:39], s54 offen
    s_add_u32 s54, s54, s52
    buffer_load_dwordx4 v[140:143], v68, s[36:39], s54 offen
    s_add_u32 s54, s54, s52
    buffer_load_dwordx4 v[144:147], v68, s[36:39], s54 offen
    s_add_u32 s54, s54, s52
    v_dot2_f32_bf16 v60, v24, v61, 0
    v_dot2_f32_bf16 v60, v25, v61, v60
    v_dot2_f32_bf16 v60, v26, v61, v60
    v_dot2_f32_bf16 v60, v27, v61, v60
    v_dot2_f32_bf16 v60, v28, v61, v60
    v_dot2_f32_bf16 v60, v29, v61, v60
    v_dot2_f32_bf16 v60, v30, v61, v60
    v_dot2_f32_bf16 v60, v31, v61, v60
    v_dot2_f32_bf16 v60, v32, v61, v60
    v_dot2_f32_bf16 v60, v33, v61, v60
    v_dot2_f32_bf16 v60, v34, v61, v60
    v_dot2_f32_bf16 v60, v35, v61, v60
    v_dot2_f32_bf16 v60, v36, v61, v60
    v_dot2_f32_bf16 v60, v37, v61, v60
    v_dot2_f32_bf16 v60, v38, v61, v60
    v_dot2_f32_bf16 v60, v39, v61, v60
    v_dot2_f32_bf16 v60, v40, v61, v60
    v_dot2_f32_bf16 v60, v41, v61, v60
    v_dot2_f32_bf16 v60, v42, v61, v60
    v_dot2_f32_bf16 v60, v43, v61, v60
    v_dot2_f32_bf16 v60, v44, v61, v60
    v_dot2_f32_bf16 v60, v45, v61, v60
    v_dot2_f32_bf16 v60, v46, v61, v60
    v_dot2_f32_bf16 v60, v47, v61, v60
    v_dot2_f32_bf16 v60, v48, v61, v60
    v_dot2_f32_bf16 v60, v49, v61, v60
    v_dot2_f32_bf16 v60, v50, v61, v60
    v_dot2_f32_bf16 v60, v51, v61, v60
    v_dot2_f32_bf16 v60, v52, v61, v60
    v_dot2_f32_bf16 v60, v53, v61, v60
    v_dot2_f32_bf16 v60, v54, v61, v60
    v_dot2_f32_bf16 v60, v55, v61, v60
    v_dot2_f32_bf16 v60, v56, v61, v60
    v_dot2_f32_bf16 v60, v57, v61, v60
    v_dot2_f32_bf16 v60, v58, v61, v60
    v_dot2_f32_bf16 v60, v59, v61, v60
    s_nop 2
    v_add_f32_dpp v60, v60, v60 row_ror:8 row_mask:0xf bank_mask:0xf
    v_mov_b32 v61, v60
    s_nop 1
    v_permlane16_swap_b32 v60, v61
    v_add_f32 v60, v60, v61
    v_mov_b32 v61, v60
    s_nop 1
    v_permlane32_swap_b32 v60, v61
    v_add_f32 v60, v60, v61
    v_mul_f32 v60, 0xbae38e39, v60
    v_mov_b32 v61, v60
    v_mov_b32 v62, 0
    v_mov_b32 v63, 0
    v_lshlrev_b32 v20, 16, v24
    v_and_b32 v21, 0xffff0000, v24
    v_pk_add_f32 v[20:21], v[20:21], v[60:61]
    v_pk_fma_f32 v[62:63], v[20:21], v[20:21], v[62:63]
    v_lshlrev_b32 v22, 16, v25
    v_and_b32 v23, 0xffff0000, v25
    v_pk_add_f32 v[22:23], v[22:23], v[60:61]
    v_pk_fma_f32 v[62:63], v[22:23], v[22:23], v[62:63]
    v_lshlrev_b32 v20, 16, v26
    v_and_b32 v21, 0xffff0000, v26
    v_pk_add_f32 v[20:21], v[20:21], v[60:61]
    v_pk_fma_f32 v[62:63], v[20:21], v[20:21], v[62:63]
    v_lshlrev_b32 v22, 16, v27
    v_and_b32 v23, 0xffff0000, v27
    v_pk_add_f32 v[22:23], v[22:23], v[60:61]
    v_pk_fma_f32 v[62:63], v[22:23], v[22:23], v[62:63]
    v_lshlrev_b32 v20, 16, v28
    v_and_b32 v21, 0xffff0000, v28
    v_pk_add_f32 v[20:21], v[20:21], v[60:61]
    v_pk_fma_f32 v[62:63], v[20:21], v[20:21], v[62:63]
    v_lshlrev_b32 v22, 16, v29
    v_and_b32 v23, 0xffff0000, v29
    v_pk_add_f32 v[22:23], v[22:23], v[60:61]
    v_pk_fma_f32 v[62:63], v[22:23], v[22:23], v[62:63]
    v_lshlrev_b32 v20, 16, v30
    v_and_b32 v21, 0xffff0000, v30
    v_pk_add_f32 v[20:21], v[20:21], v[60:61]
    v_pk_fma_f32 v[62:63], v[20:21], v[20:21], v[62:63]
    v_lshlrev_b32 v22, 16, v31
    v_and_b32 v23, 0xffff0000, v31
    v_pk_add_f32 v[22:23], v[22:23], v[60:61]
    v_pk_fma_f32 v[62:63], v[22:23], v[22:23], v[62:63]
    v_lshlrev_b32 v20, 16, v32
    v_and_b32 v21, 0xffff0000, v32
    v_pk_add_f32 v[20:21], v[20:21], v[60:61]
    v_pk_fma_f32 v[62:63], v[20:21], v[20:21], v[62:63]
    v_lshlrev_b32 v22, 16, v33
    v_and_b32 v23, 0xffff0000, v33
    v_pk_add_f32 v[22:23], v[22:23], v[60:61]
    v_pk_fma_f32 v[62:63], v[22:23], v[22:23], v[62:63]
    v_lshlrev_b32 v20, 16, v34
    v_and_b32 v21, 0xffff0000, v34
    v_pk_add_f32 v[20:21], v[20:21], v[60:61]
    v_pk_fma_f32 v[62:63], v[20:21], v[20:21], v[62:63]
    v_lshlrev_b32 v22, 16, v35
    v_and_b32 v23, 0xffff0000, v35
    v_pk_add_f32 v[22:23], v[22:23], v[60:61]
    v_pk_fma_f32 v[62:63], v[22:23], v[22:23], v[62:63]
    v_lshlrev_b32 v20, 16, v36
    v_and_b32 v21, 0xffff0000, v36
    v_pk_add_f32 v[20:21], v[20:21], v[60:61]
    v_pk_fma_f32 v[62:63], v[20:21], v[20:21], v[62:63]
    v_lshlrev_b32 v22, 16, v37
    v_and_b32 v23, 0xffff0000, v37
    v_pk_add_f32 v[22:23], v[22:23], v[60:61]
    v_pk_fma_f32 v[62:63], v[22:23], v[22:23], v[62:63]
    v_lshlrev_b32 v20, 16, v38
    v_and_b32 v21, 0xffff0000, v38
    v_pk_add_f32 v[20:21], v[20:21], v[60:61]
    v_pk_fma_f32 v[62:63], v[20:21], v[20:21], v[62:63]
    v_lshlrev_b32 v22, 16, v39
    v_and_b32 v23, 0xffff0000, v39
    v_pk_add_f32 v[22:23], v[22:23], v[60:61]
    v_pk_fma_f32 v[62:63], v[22:23], v[22:23], v[62:63]
    v_lshlrev_b32 v20, 16, v40
    v_and_b32 v21, 0xffff0000, v40
    v_pk_add_f32 v[20:21], v[20:21], v[60:61]
    v_pk_fma_f32 v[62:63], v[20:21], v[20:21], v[62:63]
    v_lshlrev_b32 v22, 16, v41
    v_and_b32 v23, 0xffff0000, v41
    v_pk_add_f32 v[22:23], v[22:23], v[60:61]
    v_pk_fma_f32 v[62:63], v[22:23], v[22:23], v[62:63]
    v_lshlrev_b32 v20, 16, v42
    v_and_b32 v21, 0xffff0000, v42
    v_pk_add_f32 v[20:21], v[20:21], v[60:61]
    v_pk_fma_f32 v[62:63], v[20:21], v[20:21], v[62:63]
    v_lshlrev_b32 v22, 16, v43
    v_and_b32 v23, 0xffff0000, v43
    v_pk_add_f32 v[22:23], v[22:23], v[60:61]
    v_pk_fma_f32 v[62:63], v[22:23], v[22:23], v[62:63]
    v_lshlrev_b32 v20, 16, v44
    v_and_b32 v21, 0xffff0000, v44
    v_pk_add_f32 v[20:21], v[20:21], v[60:61]
    v_pk_fma_f32 v[62:63], v[20:21], v[20:21], v[62:63]
    v_lshlrev_b32 v22, 16, v45
    v_and_b32 v23, 0xffff0000, v45
    v_pk_add_f32 v[22:23], v[22:23], v[60:61]
    v_pk_fma_f32 v[62:63], v[22:23], v[22:23], v[62:63]
    v_lshlrev_b32 v20, 16, v46
    v_and_b32 v21, 0xffff0000, v46
    v_pk_add_f32 v[20:21], v[20:21], v[60:61]
    v_pk_fma_f32 v[62:63], v[20:21], v[20:21], v[62:63]
    v_lshlrev_b32 v22, 16, v47
    v_and_b32 v23, 0xffff0000, v47
    v_pk_add_f32 v[22:23], v[22:23], v[60:61]
    v_pk_fma_f32 v[62:63], v[22:23], v[22:23], v[62:63]
    v_lshlrev_b32 v20, 16, v48
    v_and_b32 v21, 0xffff0000, v48
    v_pk_add_f32 v[20:21], v[20:21], v[60:61]
    v_pk_fma_f32 v[62:63], v[20:21], v[20:21], v[62:63]
    v_lshlrev_b32 v22, 16, v49
    v_and_b32 v23, 0xffff0000, v49
    v_pk_add_f32 v[22:23], v[22:23], v[60:61]
    v_pk_fma_f32 v[62:63], v[22:23], v[22:23], v[62:63]
    v_lshlrev_b32 v20, 16, v50
    v_and_b32 v21, 0xffff0000, v50
    v_pk_add_f32 v[20:21], v[20:21], v[60:61]
    v_pk_fma_f32 v[62:63], v[20:21], v[20:21], v[62:63]
    v_lshlrev_b32 v22, 16, v51
    v_and_b32 v23, 0xffff0000, v51
    v_pk_add_f32 v[22:23], v[22:23], v[60:61]
    v_pk_fma_f32 v[62:63], v[22:23], v[22:23], v[62:63]
    v_lshlrev_b32 v20, 16, v52
    v_and_b32 v21, 0xffff0000, v52
    v_pk_add_f32 v[20:21], v[20:21], v[60:61]
    v_pk_fma_f32 v[62:63], v[20:21], v[20:21], v[62:63]
    v_lshlrev_b32 v22, 16, v53
    v_and_b32 v23, 0xffff0000, v53
    v_pk_add_f32 v[22:23], v[22:23], v[60:61]
    v_pk_fma_f32 v[62:63], v[22:23], v[22:23], v[62:63]
    v_lshlrev_b32 v20, 16, v54
    v_and_b32 v21, 0xffff0000, v54
    v_pk_add_f32 v[20:21], v[20:21], v[60:61]
    v_pk_fma_f32 v[62:63], v[20:21], v[20:21], v[62:63]
    v_lshlrev_b32 v22, 16, v55
    v_and_b32 v23, 0xffff0000, v55
    v_pk_add_f32 v[22:23], v[22:23], v[60:61]
    v_pk_fma_f32 v[62:63], v[22:23], v[22:23], v[62:63]
    v_lshlrev_b32 v20, 16, v56
    v_and_b32 v21, 0xffff0000, v56
    v_pk_add_f32 v[20:21], v[20:21], v[60:61]
    v_pk_fma_f32 v[62:63], v[20:21], v[20:21], v[62:63]
    v_lshlrev_b32 v22, 16, v57
    v_and_b32 v23, 0xffff0000, v57
    v_pk_add_f32 v[22:23], v[22:23], v[60:61]
    v_pk_fma_f32 v[62:63], v[22:23], v[22:23], v[62:63]
    v_lshlrev_b32 v20, 16, v58
    v_and_b32 v21, 0xffff0000, v58
    v_pk_add_f32 v[20:21], v[20:21], v[60:61]
    v_pk_fma_f32 v[62:63], v[20:21], v[20:21], v[62:63]
    v_lshlrev_b32 v22, 16, v59
    v_and_b32 v23, 0xffff0000, v59
    v_pk_add_f32 v[22:23], v[22:23], v[60:61]
    v_pk_fma_f32 v[62:63], v[22:23], v[22:23], v[62:63]
    v_add_f32 v62, v62, v63
    s_nop 1
    v_add_f32_dpp v62, v62, v62 row_ror:8 row_mask:0xf bank_mask:0xf
    v_mov_b32 v63, v62
    s_nop 1
    v_permlane16_swap_b32 v62, v63
    v_add_f32 v62, v62, v63
    v_mov_b32 v63, v62
    s_nop 1
    v_permlane32_swap_b32 v62, v63
    v_add_f32 v62, v62, v63
    v_mul_f32 v62, 0x3ae38e39, v62
    v_sub_f32 v60, 0, v60
    v_cvt_pk_bf16_f32 v61, v60, v60
    v_and_b32 v61, 0xffff0000, v61
    v_cvt_pk_bf16_f32 v63, v62, v62
    v_and_b32 v63, 0xffff0000, v63
    v_add_f32 v63, 0x3727c5ac, v63
    v_cvt_pk_bf16_f32 v63, v63, v63
    v_and_b32 v63, 0xffff0000, v63
    v_sqrt_f32 v63, v63
    s_nop 0
    v_cvt_pk_bf16_f32 v63, v63, v63
    v_and_b32 v63, 0xffff0000, v63
    v_rcp_f32 v22, v63
    v_lshlrev_b32 v24, 16, v8
    v_and_b32 v25, 0xffff0000, v8
    v_sub_f32 v24, v24, v61
    v_sub_f32 v25, v25, v61
    v_cvt_pk_bf16_f32 v25, v24, v25
    v_lshlrev_b32 v24, 16, v25
    v_and_b32 v25, 0xffff0000, v25
    v_mul_f32 v26, v24, v22
    v_fma_f32 v27, -v26, v63, v24
    v_fma_f32 v26, v27, v22, v26
    v_mul_f32 v24, v25, v22
    v_fma_f32 v27, -v24, v63, v25
    v_fma_f32 v24, v27, v22, v24
    v_cvt_pk_bf16_f32 v8, v26, v24
    v_lshlrev_b32 v24, 16, v9
    v_and_b32 v25, 0xffff0000, v9
    v_sub_f32 v24, v24, v61
    v_sub_f32 v25, v25, v61
    v_cvt_pk_bf16_f32 v25, v24, v25
    v_lshlrev_b32 v24, 16, v25
    v_and_b32 v25, 0xffff0000, v25
    v_mul_f32 v26, v24, v22
    v_fma_f32 v27, -v26, v63, v24
    v_fma_f32 v26, v27, v22, v26
    v_mul_f32 v24, v25, v22
    v_fma_f32 v27, -v24, v63, v25
    v_fma_f32 v24, v27, v22, v24
    v_cvt_pk_bf16_f32 v9, v26, v24
    v_lshlrev_b32 v24, 16, v10
    v_and_b32 v25, 0xffff0000, v10
    v_sub_f32 v24, v24, v61
    v_sub_f32 v25, v25, v61
    v_cvt_pk_bf16_f32 v25, v24, v25
    v_lshlrev_b32 v24, 16, v25
    v_and_b32 v25, 0xffff0000, v25
    v_mul_f32 v26, v24, v22
    v_fma_f32 v27, -v26, v63, v24
    v_fma_f32 v26, v27, v22, v26
    v_mul_f32 v24, v25, v22
    v_fma_f32 v27, -v24, v63, v25
    v_fma_f32 v24, v27, v22, v24
    v_cvt_pk_bf16_f32 v10, v26, v24
    v_lshlrev_b32 v24, 16, v11
    v_and_b32 v25, 0xffff0000, v11
    v_sub_f32 v24, v24, v61
    v_sub_f32 v25, v25, v61
    v_cvt_pk_bf16_f32 v25, v24, v25
    v_lshlrev_b32 v24, 16, v25
    v_and_b32 v25, 0xffff0000, v25
    v_mul_f32 v26, v24, v22
    v_fma_f32 v27, -v26, v63, v24
    v_fma_f32 v26, v27, v22, v26
    v_mul_f32 v24, v25, v22
    v_fma_f32 v27, -v24, v63, v25
    v_fma_f32 v24, v27, v22, v24
    v_cvt_pk_bf16_f32 v11, v26, v24
    v_lshlrev_b32 v24, 16, v12
    v_and_b32 v25, 0xffff0000, v12
    v_sub_f32 v24, v24, v61
    v_sub_f32 v25, v25, v61
    v_cvt_pk_bf16_f32 v25, v24, v25
    v_lshlrev_b32 v24, 16, v25
    v_and_b32 v25, 0xffff0000, v25
    v_mul_f32 v26, v24, v22
    v_fma_f32 v27, -v26, v63, v24
    v_fma_f32 v26, v27, v22, v26
    v_mul_f32 v24, v25, v22
    v_fma_f32 v27, -v24, v63, v25
    v_fma_f32 v24, v27, v22, v24
    v_cvt_pk_bf16_f32 v12, v26, v24
    v_lshlrev_b32 v24, 16, v13
    v_and_b32 v25, 0xffff0000, v13
    v_sub_f32 v24, v24, v61
    v_sub_f32 v25, v25, v61
    v_cvt_pk_bf16_f32 v25, v24, v25
    v_lshlrev_b32 v24, 16, v25
    v_and_b32 v25, 0xffff0000, v25
    v_mul_f32 v26, v24, v22
    v_fma_f32 v27, -v26, v63, v24
    v_fma_f32 v26, v27, v22, v26
    v_mul_f32 v24, v25, v22
    v_fma_f32 v27, -v24, v63, v25
    v_fma_f32 v24, v27, v22, v24
    v_cvt_pk_bf16_f32 v13, v26, v24
    v_lshlrev_b32 v24, 16, v14
    v_and_b32 v25, 0xffff0000, v14
    v_sub_f32 v24, v24, v61
    v_sub_f32 v25, v25, v61
    v_cvt_pk_bf16_f32 v25, v24, v25
    v_lshlrev_b32 v24, 16, v25
    v_and_b32 v25, 0xffff0000, v25
    v_mul_f32 v26, v24, v22
    v_fma_f32 v27, -v26, v63, v24
    v_fma_f32 v26, v27, v22, v26
    v_mul_f32 v24, v25, v22
    v_fma_f32 v27, -v24, v63, v25
    v_fma_f32 v24, v27, v22, v24
    v_cvt_pk_bf16_f32 v14, v26, v24
    v_lshlrev_b32 v24, 16, v15
    v_and_b32 v25, 0xffff0000, v15
    v_sub_f32 v24, v24, v61
    v_sub_f32 v25, v25, v61
    v_cvt_pk_bf16_f32 v25, v24, v25
    v_lshlrev_b32 v24, 16, v25
    v_and_b32 v25, 0xffff0000, v25
    v_mul_f32 v26, v24, v22
    v_fma_f32 v27, -v26, v63, v24
    v_fma_f32 v26, v27, v22, v26
    v_mul_f32 v24, v25, v22
    v_fma_f32 v27, -v24, v63, v25
    v_fma_f32 v24, v27, v22, v24
    v_cvt_pk_bf16_f32 v15, v26, v24
    v_lshlrev_b32 v24, 16, v16
    v_and_b32 v25, 0xffff0000, v16
    v_sub_f32 v24, v24, v61
    v_sub_f32 v25, v25, v61
    v_cvt_pk_bf16_f32 v25, v24, v25
    v_lshlrev_b32 v24, 16, v25
    v_and_b32 v25, 0xffff0000, v25
    v_mul_f32 v26, v24, v22
    v_fma_f32 v27, -v26, v63, v24
    v_fma_f32 v26, v27, v22, v26
    v_mul_f32 v24, v25, v22
    v_fma_f32 v27, -v24, v63, v25
    v_fma_f32 v24, v27, v22, v24
    v_cvt_pk_bf16_f32 v16, v26, v24
    v_lshlrev_b32 v24, 16, v17
    v_and_b32 v25, 0xffff0000, v17
    v_sub_f32 v24, v24, v61
    v_sub_f32 v25, v25, v61
    v_cvt_pk_bf16_f32 v25, v24, v25
    v_lshlrev_b32 v24, 16, v25
    v_and_b32 v25, 0xffff0000, v25
    v_mul_f32 v26, v24, v22
    v_fma_f32 v27, -v26, v63, v24
    v_fma_f32 v26, v27, v22, v26
    v_mul_f32 v24, v25, v22
    v_fma_f32 v27, -v24, v63, v25
    v_fma_f32 v24, v27, v22, v24
    v_cvt_pk_bf16_f32 v17, v26, v24
    v_lshlrev_b32 v24, 16, v18
    v_and_b32 v25, 0xffff0000, v18
    v_sub_f32 v24, v24, v61
    v_sub_f32 v25, v25, v61
    v_cvt_pk_bf16_f32 v25, v24, v25
    v_lshlrev_b32 v24, 16, v25
    v_and_b32 v25, 0xffff0000, v25
    v_mul_f32 v26, v24, v22
    v_fma_f32 v27, -v26, v63, v24
    v_fma_f32 v26, v27, v22, v26
    v_mul_f32 v24, v25, v22
    v_fma_f32 v27, -v24, v63, v25
    v_fma_f32 v24, v27, v22, v24
    v_cvt_pk_bf16_f32 v18, v26, v24
    v_lshlrev_b32 v24, 16, v19
    v_and_b32 v25, 0xffff0000, v19
    v_sub_f32 v24, v24, v61
    v_sub_f32 v25, v25, v61
    v_cvt_pk_bf16_f32 v25, v24, v25
    v_lshlrev_b32 v24, 16, v25
    v_and_b32 v25, 0xffff0000, v25
    v_mul_f32 v26, v24, v22
    v_fma_f32 v27, -v26, v63, v24
    v_fma_f32 v26, v27, v22, v26
    v_mul_f32 v24, v25, v22
    v_fma_f32 v27, -v24, v63, v25
    v_fma_f32 v24, v27, v22, v24
    v_cvt_pk_bf16_f32 v19, v26, v24
    s_waitcnt vmcnt(2)
    buffer_load_dwordx4 v[148:151], v68, s[36:39], s54 offen
    s_add_u32 s54, s54, s52
    s_waitcnt vmcnt(2)
    buffer_load_dwordx4 v[152:155], v68, s[36:39], s54 offen
    s_add_u32 s54, s54, s52
    s_waitcnt vmcnt(2)
    buffer_load_dwordx4 v[156:159], v68, s[36:39], s54 offen
    s_add_u32 s54, s54, s52
    s_waitcnt vmcnt(2)
    buffer_load_dwordx4 v[160:163], v68, s[36:39], s54 offen
    s_add_u32 s54, s54, s52
    s_waitcnt vmcnt(2)
    buffer_load_dwordx4 v[164:167], v68, s[36:39], s54 offen
    s_add_u32 s54, s54, s53
    s_waitcnt vmcnt(2)
    buffer_load_dwordx4 v[72:75], v68, s[36:39], s54 offen
    s_add_u32 s54, s54, s52
    s_waitcnt vmcnt(2)
    buffer_load_dwordx4 v[76:79], v68, s[36:39], s54 offen
    s_add_u32 s54, s54, s52
    s_waitcnt vmcnt(2)
    buffer_load_dwordx4 v[80:83], v68, s[36:39], s54 offen
    s_add_u32 s54, s54, s52
    s_waitcnt vmcnt(2)
    buffer_load_dwordx4 v[84:87], v68, s[36:39], s54 offen
    s_add_u32 s54, s54, s52
    s_waitcnt vmcnt(2)
    buffer_load_dwordx4 v[88:91], v68, s[36:39], s54 offen
    s_add_u32 s54, s54, s52
    s_waitcnt vmcnt(2)
    buffer_load_dwordx4 v[92:95], v68, s[36:39], s54 offen
    s_add_u32 s54, s54, s52
    s_waitcnt vmcnt(2)
    buffer_load_dwordx4 v[96:99], v68, s[36:39], s54 offen
    s_add_u32 s54, s54, s52
    s_waitcnt vmcnt(2)
    buffer_load_dwordx4 v[100:103], v68, s[36:39], s54 offen
    s_add_u32 s54, s54, s53
    v_mov_b32 v21, 0
L_lwn1:
    ds_read_b32 v22, v21 offset:6224
    s_waitcnt lgkmcnt(0)
    v_readfirstlane_b32 s33, v22
    s_nop 0
    s_cmp_ge_u32 s33, 1
    s_cbranch_scc1 L_lgn1
    s_sleep 8
    s_branch L_lwn1
L_lgn1:
    s_branch L_mm
L_dn:
    s_waitcnt vmcnt(2)
    buffer_load_dwordx4 v[136:139], v68, s[36:39], s54 offen
    s_add_u32 s54, s54, s52
    s_waitcnt vmcnt(2)
    buffer_load_dwordx4 v[140:143], v68, s[36:39], s54 offen
    s_add_u32 s54, s54, s52
    s_waitcnt vmcnt(2)
    buffer_load_dwordx4 v[144:147], v68, s[36:39], s54 offen
    s_add_u32 s54, s54, s52
    s_waitcnt vmcnt(2)
    buffer_load_dwordx4 v[148:151], v68, s[36:39], s54 offen
    s_add_u32 s54, s54, s52
    s_waitcnt vmcnt(2)
    buffer_load_dwordx4 v[152:155], v68, s[36:39], s54 offen
    s_add_u32 s54, s54, s52
    s_waitcnt vmcnt(2)
    buffer_load_dwordx4 v[156:159], v68, s[36:39], s54 offen
    s_add_u32 s54, s54, s52
    s_waitcnt vmcnt(2)
    buffer_load_dwordx4 v[160:163], v68, s[36:39], s54 offen
    s_add_u32 s54, s54, s52
    s_waitcnt vmcnt(2)
    buffer_load_dwordx4 v[164:167], v68, s[36:39], s54 offen
    s_add_u32 s54, s54, s53
    s_waitcnt vmcnt(2)
    buffer_load_dwordx4 v[72:75], v68, s[36:39], s54 offen
    s_add_u32 s54, s54, s52
    s_waitcnt vmcnt(2)
    buffer_load_dwordx4 v[76:79], v68, s[36:39], s54 offen
    s_add_u32 s54, s54, s52
    s_waitcnt vmcnt(2)
    buffer_load_dwordx4 v[80:83], v68, s[36:39], s54 offen
    s_add_u32 s54, s54, s52
    s_waitcnt vmcnt(2)
    buffer_load_dwordx4 v[84:87], v68, s[36:39], s54 offen
    s_add_u32 s54, s54, s52
    s_waitcnt vmcnt(2)
    buffer_load_dwordx4 v[88:91], v68, s[36:39], s54 offen
    s_add_u32 s54, s54, s52
    s_waitcnt vmcnt(2)
    buffer_load_dwordx4 v[92:95], v68, s[36:39], s54 offen
    s_add_u32 s54, s54, s52
    s_waitcnt vmcnt(2)
    buffer_load_dwordx4 v[96:99], v68, s[36:39], s54 offen
    s_add_u32 s54, s54, s52
    s_waitcnt vmcnt(2)
    buffer_load_dwordx4 v[100:103], v68, s[36:39], s54 offen
    s_add_u32 s54, s54, s53
    v_mov_b32 v21, 0
L_lwn2:
    ds_read_b32 v22, v21 offset:6224
    s_waitcnt lgkmcnt(0)
    v_readfirstlane_b32 s33, v22
    s_nop 0
    s_cmp_ge_u32 s33, 1
    s_cbranch_scc1 L_lgn2
    s_sleep 8
    s_branch L_lwn2
L_lgn2:
    v_bfe_u32 v21, v1, 0, 1
    v_lshlrev_b32 v21, 4, v21
    v_bfe_u32 v21, v22, v21, 16
    s_mul_i32 s33, s69, 9
    s_mul_i32 s34, s68, 3
    s_add_u32 s33, s33, s34
    s_lshl_b32 s33, s33, 12
    s_add_u32 s33, s33, 0x100000
    s_mov_b32 s35, 0
    s_add_u32 s34, s33, 8192
    s_mov_b64 exec, 0xff
L_hq:
    buffer_load_dwordx4 v[24:27], v2, s[48:51], s34 offen sc1
    buffer_load_dwordx4 v[28:31], v2, s[48:51], s34 offen offset:2048 sc1
    s_waitcnt vmcnt(0)
    v_bitop3_b32 v8, v24, v28, v21 bitop3:0x7e
    v_and_b32 v8, 0xffff, v8
    v_cmp_ne_u32 vcc, 0, v8
    s_cbranch_vccz L_hqo
    s_add_u32 s35, s35, 1
    s_cmp_gt_u32 s35, 0x40000
    s_cbranch_scc1 L_hqo
    s_sleep 127
    s_branch L_hq
L_hqo:
    s_mov_b64 exec, -1
L_hp:
    s_mov_b32 s34, s33
    buffer_load_dwordx4 v[24:27], v2, s[48:51], s34 offen offset:0 sc1
    buffer_load_dwordx4 v[28:31], v2, s[48:51], s34 offen offset:1024 sc1
    buffer_load_dwordx4 v[32:35], v2, s[48:51], s34 offen offset:2048 sc1
    buffer_load_dwordx4 v[36:39], v2, s[48:51], s34 offen offset:3072 sc1
    s_add_u32 s34, s34, 4096
    buffer_load_dwordx4 v[40:43], v2, s[48:51], s34 offen offset:0 sc1
    buffer_load_dwordx4 v[44:47], v2, s[48:51], s34 offen offset:1024 sc1
    buffer_load_dwordx4 v[48:51], v2, s[48:51], s34 offen offset:2048 sc1
    buffer_load_dwordx4 v[52:55], v2, s[48:51], s34 offen offset:3072 sc1
    s_add_u32 s34, s34, 4096
    buffer_load_dwordx4 v[56:59], v2, s[48:51], s34 offen offset:0 sc1
    buffer_load_dwordx4 v[60:63], v2, s[48:51], s34 offen offset:1024 sc1
    buffer_load_dwordx4 v[64:67], v2, s[48:51], s34 offen offset:2048 sc1
    buffer_load_dwordx4 v[68:71], v2, s[48:51], s34 offen offset:3072 sc1
    s_waitcnt vmcnt(0)
    v_mov_b32 v20, 0
    v_bitop3_b32 v8, v24, v25, v21 bitop3:0x7e
    v_bitop3_b32 v9, v26, v27, v21 bitop3:0x7e
    v_or3_b32 v20, v20, v8, v9
    v_bitop3_b32 v8, v28, v29, v21 bitop3:0x7e
    v_bitop3_b32 v9, v30, v31, v21 bitop3:0x7e
    v_or3_b32 v20, v20, v8, v9
    v_bitop3_b32 v8, v32, v33, v21 bitop3:0x7e
    v_bitop3_b32 v9, v34, v35, v21 bitop3:0x7e
    v_or3_b32 v20, v20, v8, v9
    v_bitop3_b32 v8, v36, v37, v21 bitop3:0x7e
    v_bitop3_b32 v9, v38, v39, v21 bitop3:0x7e
    v_or3_b32 v20, v20, v8, v9
    v_bitop3_b32 v8, v40, v41, v21 bitop3:0x7e
    v_bitop3_b32 v9, v42, v43, v21 bitop3:0x7e
    v_or3_b32 v20, v20, v8, v9
    v_bitop3_b32 v8, v44, v45, v21 bitop3:0x7e
    v_bitop3_b32 v9, v46, v47, v21 bitop3:0x7e
    v_or3_b32 v20, v20, v8, v9
    v_bitop3_b32 v8, v48, v49, v21 bitop3:0x7e
    v_bitop3_b32 v9, v50, v51, v21 bitop3:0x7e
    v_or3_b32 v20, v20, v8, v9
    v_bitop3_b32 v8, v52, v53, v21 bitop3:0x7e
    v_bitop3_b32 v9, v54, v55, v21 bitop3:0x7e
    v_or3_b32 v20, v20, v8, v9
    v_bitop3_b32 v8, v56, v57, v21 bitop3:0x7e
    v_bitop3_b32 v9, v58, v59, v21 bitop3:0x7e
    v_or3_b32 v20, v20, v8, v9
    v_bitop3_b32 v8, v60, v61, v21 bitop3:0x7e
    v_bitop3_b32 v9, v62, v63, v21 bitop3:0x7e
    v_or3_b32 v20, v20, v8, v9
    v_bitop3_b32 v8, v64, v65, v21 bitop3:0x7e
    v_bitop3_b32 v9, v66, v67, v21 bitop3:0x7e
    v_or3_b32 v20, v20, v8, v9
    v_bitop3_b32 v8, v68, v69, v21 bitop3:0x7e
    v_bitop3_b32 v9, v70, v71, v21 bitop3:0x7e
    v_or3_b32 v20, v20, v8, v9
    v_and_b32 v20, 0xffff, v20
    v_cmp_ne_u32 vcc, 0, v20
    s_cbranch_vccz L_hok
    s_add_u32 s35, s35, 1
    s_cmp_gt_u32 s35, 0x40000
    s_cbranch_scc1 L_hok
    s_sleep 127
    s_branch L_hp
L_hok:
    v_and_b32 v24, 0xffff0000, v24
    v_and_b32 v32, 0xffff0000, v32
    v_mul_f32 v24, v24, v32
    v_and_b32 v25, 0xffff0000, v25
    v_and_b32 v33, 0xffff0000, v33
    v_mul_f32 v25, v25, v33
    v_and_b32 v26, 0xffff0000, v26
    v_and_b32 v34, 0xffff0000, v34
    v_mul_f32 v26, v26, v34
    v_and_b32 v27, 0xffff0000, v27
    v_and_b32 v35, 0xffff0000, v35
    v_mul_f32 v27, v27, v35
    v_cvt_pk_bf16_f32 v8, v24, v25
    v_cvt_pk_bf16_f32 v9, v26, v27
    v_and_b32 v28, 0xffff0000, v28
    v_and_b32 v36, 0xffff0000, v36
    v_mul_f32 v28, v28, v36
    v_and_b32 v29, 0xffff0000, v29
    v_and_b32 v37, 0xffff0000, v37
    v_mul_f32 v29, v29, v37
    v_and_b32 v30, 0xffff0000, v30
    v_and_b32 v38, 0xffff0000, v38
    v_mul_f32 v30, v30, v38
    v_and_b32 v31, 0xffff0000, v31
    v_and_b32 v39, 0xffff0000, v39
    v_mul_f32 v31, v31, v39
    v_cvt_pk_bf16_f32 v10, v28, v29
    v_cvt_pk_bf16_f32 v11, v30, v31
    v_and_b32 v40, 0xffff0000, v40
    v_and_b32 v48, 0xffff0000, v48
    v_mul_f32 v40, v40, v48
    v_and_b32 v41, 0xffff0000, v41
    v_and_b32 v49, 0xffff0000, v49
    v_mul_f32 v41, v41, v49
    v_and_b32 v42, 0xffff0000, v42
    v_and_b32 v50, 0xffff0000, v50
    v_mul_f32 v42, v42, v50
    v_and_b32 v43, 0xffff0000, v43
    v_and_b32 v51, 0xffff0000, v51
    v_mul_f32 v43, v43, v51
    v_cvt_pk_bf16_f32 v12, v40, v41
    v_cvt_pk_bf16_f32 v13, v42, v43
    v_and_b32 v44, 0xffff0000, v44
    v_and_b32 v52, 0xffff0000, v52
    v_mul_f32 v44, v44, v52
    v_and_b32 v45, 0xffff0000, v45
    v_and_b32 v53, 0xffff0000, v53
    v_mul_f32 v45, v45, v53
    v_and_b32 v46, 0xffff0000, v46
    v_and_b32 v54, 0xffff0000, v54
    v_mul_f32 v46, v46, v54
    v_and_b32 v47, 0xffff0000, v47
    v_and_b32 v55, 0xffff0000, v55
    v_mul_f32 v47, v47, v55
    v_cvt_pk_bf16_f32 v14, v44, v45
    v_cvt_pk_bf16_f32 v15, v46, v47
    v_and_b32 v56, 0xffff0000, v56
    v_and_b32 v64, 0xffff0000, v64
    v_mul_f32 v56, v56, v64
    v_and_b32 v57, 0xffff0000, v57
    v_and_b32 v65, 0xffff0000, v65
    v_mul_f32 v57, v57, v65
    v_and_b32 v58, 0xffff0000, v58
    v_and_b32 v66, 0xffff0000, v66
    v_mul_f32 v58, v58, v66
    v_and_b32 v59, 0xffff0000, v59
    v_and_b32 v67, 0xffff0000, v67
    v_mul_f32 v59, v59, v67
    v_cvt_pk_bf16_f32 v16, v56, v57
    v_cvt_pk_bf16_f32 v17, v58, v59
    v_and_b32 v60, 0xffff0000, v60
    v_and_b32 v68, 0xffff0000, v68
    v_mul_f32 v60, v60, v68
    v_and_b32 v61, 0xffff0000, v61
    v_and_b32 v69, 0xffff0000, v69
    v_mul_f32 v61, v61, v69
    v_and_b32 v62, 0xffff0000, v62
    v_and_b32 v70, 0xffff0000, v70
    v_mul_f32 v62, v62, v70
    v_and_b32 v63, 0xffff0000, v63
    v_and_b32 v71, 0xffff0000, v71
    v_mul_f32 v63, v63, v71
    v_cvt_pk_bf16_f32 v18, v60, v61
    v_cvt_pk_bf16_f32 v19, v62, v63
L_mm:
    s_waitcnt vmcnt(16)
    v_perm_b32 v24, v108, v104, s60
    v_perm_b32 v25, v116, v112, s60
    v_perm_b32 v26, v124, v120, s60
    v_perm_b32 v27, v132, v128, s60
    s_nop 1
    v_mfma_f32_16x16x32_bf16 v[32:35], v[8:11], v[24:27], 0
    v_perm_b32 v28, v108, v104, s61
    v_perm_b32 v29, v116, v112, s61
    v_perm_b32 v30, v124, v120, s61
    v_perm_b32 v31, v132, v128, s61
    s_nop 1
    v_mfma_f32_16x16x32_bf16 v[36:39], v[8:11], v[28:31], 0
    v_perm_b32 v24, v109, v105, s60
    v_perm_b32 v25, v117, v113, s60
    v_perm_b32 v26, v125, v121, s60
    v_perm_b32 v27, v133, v129, s60
    s_nop 1
    v_mfma_f32_16x16x32_bf16 v[40:43], v[8:11], v[24:27], 0
    v_perm_b32 v28, v109, v105, s61
    v_perm_b32 v29, v117, v113, s61
    v_perm_b32 v30, v125, v121, s61
    v_perm_b32 v31, v133, v129, s61
    s_nop 1
    v_mfma_f32_16x16x32_bf16 v[44:47], v[8:11], v[28:31], 0
    v_perm_b32 v24, v110, v106, s60
    v_perm_b32 v25, v118, v114, s60
    v_perm_b32 v26, v126, v122, s60
    v_perm_b32 v27, v134, v130, s60
    s_nop 1
    v_mfma_f32_16x16x32_bf16 v[48:51], v[8:11], v[24:27], 0
    v_perm_b32 v28, v110, v106, s61
    v_perm_b32 v29, v118, v114, s61
    v_perm_b32 v30, v126, v122, s61
    v_perm_b32 v31, v134, v130, s61
    s_nop 1
    v_mfma_f32_16x16x32_bf16 v[52:55], v[8:11], v[28:31], 0
    v_perm_b32 v24, v111, v107, s60
    v_perm_b32 v25, v119, v115, s60
    v_perm_b32 v26, v127, v123, s60
    v_perm_b32 v27, v135, v131, s60
    s_nop 1
    v_mfma_f32_16x16x32_bf16 v[56:59], v[8:11], v[24:27], 0
    v_perm_b32 v28, v111, v107, s61
    v_perm_b32 v29, v119, v115, s61
    v_perm_b32 v30, v127, v123, s61
    v_perm_b32 v31, v135, v131, s61
    s_nop 1
    v_mfma_f32_16x16x32_bf16 v[60:63], v[8:11], v[28:31], 0
    s_waitcnt vmcnt(8)
    v_perm_b32 v24, v140, v136, s60
    v_perm_b32 v25, v148, v144, s60
    v_perm_b32 v26, v156, v152, s60
    v_perm_b32 v27, v164, v160, s60
    s_nop 1
    v_mfma_f32_16x16x32_bf16 v[32:35], v[12:15], v[24:27], v[32:35]
    v_perm_b32 v28, v140, v136, s61
    v_perm_b32 v29, v148, v144, s61
    v_perm_b32 v30, v156, v152, s61
    v_perm_b32 v31, v164, v160, s61
    s_nop 1
    v_mfma_f32_16x16x32_bf16 v[36:39], v[12:15], v[28:31], v[36:39]
    v_perm_b32 v24, v141, v137, s60
    v_perm_b32 v25, v149, v145, s60
    v_perm_b32 v26, v157, v153, s60
    v_perm_b32 v27, v165, v161, s60
    s_nop 1
    v_mfma_f32_16x16x32_bf16 v[40:43], v[12:15], v[24:27], v[40:43]
    v_perm_b32 v28, v141, v137, s61
    v_perm_b32 v29, v149, v145, s61
    v_perm_b32 v30, v157, v153, s61
    v_perm_b32 v31, v165, v161, s61
    s_nop 1
    v_mfma_f32_16x16x32_bf16 v[44:47], v[12:15], v[28:31], v[44:47]
    v_perm_b32 v24, v142, v138, s60
    v_perm_b32 v25, v150, v146, s60
    v_perm_b32 v26, v158, v154, s60
    v_perm_b32 v27, v166, v162, s60
    s_nop 1
    v_mfma_f32_16x16x32_bf16 v[48:51], v[12:15], v[24:27], v[48:51]
    v_perm_b32 v28, v142, v138, s61
    v_perm_b32 v29, v150, v146, s61
    v_perm_b32 v30, v158, v154, s61
    v_perm_b32 v31, v166, v162, s61
    s_nop 1
    v_mfma_f32_16x16x32_bf16 v[52:55], v[12:15], v[28:31], v[52:55]
    v_perm_b32 v24, v143, v139, s60
    v_perm_b32 v25, v151, v147, s60
    v_perm_b32 v26, v159, v155, s60
    v_perm_b32 v27, v167, v163, s60
    s_nop 1
    v_mfma_f32_16x16x32_bf16 v[56:59], v[12:15], v[24:27], v[56:59]
    v_perm_b32 v28, v143, v139, s61
    v_perm_b32 v29, v151, v147, s61
    v_perm_b32 v30, v159, v155, s61
    v_perm_b32 v31, v167, v163, s61
    s_nop 1
    v_mfma_f32_16x16x32_bf16 v[60:63], v[12:15], v[28:31], v[60:63]
    s_waitcnt vmcnt(0)
    v_perm_b32 v24, v76, v72, s60
    v_perm_b32 v25, v84, v80, s60
    v_perm_b32 v26, v92, v88, s60
    v_perm_b32 v27, v100, v96, s60
    s_nop 1
    v_mfma_f32_16x16x32_bf16 v[32:35], v[16:19], v[24:27], v[32:35]
    v_perm_b32 v28, v76, v72, s61
    v_perm_b32 v29, v84, v80, s61
    v_perm_b32 v30, v92, v88, s61
    v_perm_b32 v31, v100, v96, s61
    s_nop 1
    v_mfma_f32_16x16x32_bf16 v[36:39], v[16:19], v[28:31], v[36:39]
    v_perm_b32 v24, v77, v73, s60
    v_perm_b32 v25, v85, v81, s60
    v_perm_b32 v26, v93, v89, s60
    v_perm_b32 v27, v101, v97, s60
    s_nop 1
    v_mfma_f32_16x16x32_bf16 v[40:43], v[16:19], v[24:27], v[40:43]
    v_perm_b32 v28, v77, v73, s61
    v_perm_b32 v29, v85, v81, s61
    v_perm_b32 v30, v93, v89, s61
    v_perm_b32 v31, v101, v97, s61
    s_nop 1
    v_mfma_f32_16x16x32_bf16 v[44:47], v[16:19], v[28:31], v[44:47]
    v_perm_b32 v24, v78, v74, s60
    v_perm_b32 v25, v86, v82, s60
    v_perm_b32 v26, v94, v90, s60
    v_perm_b32 v27, v102, v98, s60
    s_nop 1
    v_mfma_f32_16x16x32_bf16 v[48:51], v[16:19], v[24:27], v[48:51]
    v_perm_b32 v28, v78, v74, s61
    v_perm_b32 v29, v86, v82, s61
    v_perm_b32 v30, v94, v90, s61
    v_perm_b32 v31, v102, v98, s61
    s_nop 1
    v_mfma_f32_16x16x32_bf16 v[52:55], v[16:19], v[28:31], v[52:55]
    v_perm_b32 v24, v79, v75, s60
    v_perm_b32 v25, v87, v83, s60
    v_perm_b32 v26, v95, v91, s60
    v_perm_b32 v27, v103, v99, s60
    s_nop 1
    v_mfma_f32_16x16x32_bf16 v[56:59], v[16:19], v[24:27], v[56:59]
    v_perm_b32 v28, v79, v75, s61
    v_perm_b32 v29, v87, v83, s61
    v_perm_b32 v30, v95, v91, s61
    v_perm_b32 v31, v103, v99, s61
    s_nop 1
    v_mfma_f32_16x16x32_bf16 v[60:63], v[16:19], v[28:31], v[60:63]
    v_permlane32_swap_b32 v32, v33
    v_permlane32_swap_b32 v34, v35
    v_permlane32_swap_b32 v36, v37
    v_permlane32_swap_b32 v38, v39
    v_permlane32_swap_b32 v40, v41
    v_permlane32_swap_b32 v42, v43
    v_permlane32_swap_b32 v44, v45
    v_permlane32_swap_b32 v46, v47
    v_permlane32_swap_b32 v48, v49
    v_permlane32_swap_b32 v50, v51
    v_permlane32_swap_b32 v52, v53
    v_permlane32_swap_b32 v54, v55
    v_permlane32_swap_b32 v56, v57
    v_permlane32_swap_b32 v58, v59
    v_permlane32_swap_b32 v60, v61
    v_permlane32_swap_b32 v62, v63
    v_add_f32_dpp v64, v33, v32 row_shl:8 row_mask:0xf bank_mask:0x3
    s_nop 1
    v_add_f32_dpp v64, v34, v35 row_shr:8 row_mask:0xf bank_mask:0xc
    v_add_f32_dpp v65, v37, v36 row_shl:8 row_mask:0xf bank_mask:0x3
    s_nop 1
    v_add_f32_dpp v65, v38, v39 row_shr:8 row_mask:0xf bank_mask:0xc
    v_add_f32_dpp v66, v41, v40 row_shl:8 row_mask:0xf bank_mask:0x3
    s_nop 1
    v_add_f32_dpp v66, v42, v43 row_shr:8 row_mask:0xf bank_mask:0xc
    v_add_f32_dpp v67, v45, v44 row_shl:8 row_mask:0xf bank_mask:0x3
    s_nop 1
    v_add_f32_dpp v67, v46, v47 row_shr:8 row_mask:0xf bank_mask:0xc
    v_add_f32_dpp v68, v49, v48 row_shl:8 row_mask:0xf bank_mask:0x3
    s_nop 1
    v_add_f32_dpp v68, v50, v51 row_shr:8 row_mask:0xf bank_mask:0xc
    v_add_f32_dpp v69, v53, v52 row_shl:8 row_mask:0xf bank_mask:0x3
    s_nop 1
    v_add_f32_dpp v69, v54, v55 row_shr:8 row_mask:0xf bank_mask:0xc
    v_add_f32_dpp v70, v57, v56 row_shl:8 row_mask:0xf bank_mask:0x3
    s_nop 1
    v_add_f32_dpp v70, v58, v59 row_shr:8 row_mask:0xf bank_mask:0xc
    v_add_f32_dpp v71, v61, v60 row_shl:8 row_mask:0xf bank_mask:0x3
    s_nop 1
    v_add_f32_dpp v71, v62, v63 row_shr:8 row_mask:0xf bank_mask:0xc
    s_lshl_b32 s33, s68, 11
    v_lshlrev_b32 v23, 5, v1
    v_add_u32 v20, s33, v23
    ds_write_b128 v20, v[64:67] offset:22400
    ds_write_b128 v20, v[68:71] offset:22416
    v_mov_b32 v21, 0
    v_mov_b32 v24, 1
    s_mov_b64 exec, 1
    ds_add_u32 v21, v24 offset:6208
    s_mov_b64 exec, -1
    s_cmp_lg_u32 s68, 0
    s_cbranch_scc1 L_fin
    v_mov_b32 v21, 0
L_lwz:
    ds_read_b32 v24, v21 offset:6208
    s_waitcnt lgkmcnt(0)
    v_readfirstlane_b32 s33, v24
    s_nop 0
    s_cmp_ge_u32 s33, 3
    s_cbranch_scc1 L_lgz
    s_sleep 2
    s_branch L_lwz
L_lgz:
    ds_read_b128 v[32:35], v23 offset:22400
    ds_read_b128 v[36:39], v23 offset:22416
    ds_read_b128 v[40:43], v23 offset:24448
    ds_read_b128 v[44:47], v23 offset:24464
    ds_read_b128 v[48:51], v23 offset:26496
    ds_read_b128 v[52:55], v23 offset:26512
    v_bfe_u32 v24, v1, 3, 2
    v_lshlrev_b32 v24, 1, v24
    v_lshrrev_b32 v25, 5, v1
    v_add_u32 v24, v24, v25
    v_and_b32 v25, 7, v1
    s_waitcnt lgkmcnt(0)
    v_pk_add_f32 v[64:65], v[32:33], v[40:41]
    v_pk_add_f32 v[66:67], v[34:35], v[42:43]
    v_pk_add_f32 v[68:69], v[36:37], v[44:45]
    v_pk_add_f32 v[70:71], v[38:39], v[46:47]
    v_pk_add_f32 v[64:65], v[64:65], v[48:49]
    v_pk_add_f32 v[66:67], v[66:67], v[50:51]
    v_pk_add_f32 v[68:69], v[68:69], v[52:53]
    v_pk_add_f32 v[70:71], v[70:71], v[54:55]
    s_cmp_ge_u32 s56, 18
    s_cbranch_scc1 L_dnp
    v_cvt_pk_bf16_f32 v64, v64, v64
    v_and_b32 v64, 0xffff0000, v64
    v_cvt_pk_bf16_f32 v65, v65, v65
    v_and_b32 v65, 0xffff0000, v65
    v_cvt_pk_bf16_f32 v66, v66, v66
    v_and_b32 v66, 0xffff0000, v66
    v_cvt_pk_bf16_f32 v67, v67, v67
    v_and_b32 v67, 0xffff0000, v67
    v_cvt_pk_bf16_f32 v68, v68, v68
    v_and_b32 v68, 0xffff0000, v68
    v_cvt_pk_bf16_f32 v69, v69, v69
    v_and_b32 v69, 0xffff0000, v69
    v_cvt_pk_bf16_f32 v70, v70, v70
    v_and_b32 v70, 0xffff0000, v70
    v_cvt_pk_bf16_f32 v71, v71, v71
    v_and_b32 v71, 0xffff0000, v71
    s_lshl_b32 s33, s57, 12
    s_add_u32 s33, s33, 0x100800
    s_cmp_ge_u32 s56, 9
    s_cbranch_scc1 L_upp
    s_sub_u32 s33, s33, 2048
    v_mul_f32 v26, 0xbfb8aa3b, v64
    v_exp_f32 v26, v26
    s_nop 0
    v_add_f32 v26, 1.0, v26
    v_rcp_f32 v26, v26
    s_nop 0
    v_mul_f32 v64, v64, v26
    v_cvt_pk_bf16_f32 v64, v64, v64
    v_and_b32 v64, 0xffff0000, v64
    v_mul_f32 v26, 0xbfb8aa3b, v65
    v_exp_f32 v26, v26
    s_nop 0
    v_add_f32 v26, 1.0, v26
    v_rcp_f32 v26, v26
    s_nop 0
    v_mul_f32 v65, v65, v26
    v_cvt_pk_bf16_f32 v65, v65, v65
    v_and_b32 v65, 0xffff0000, v65
    v_mul_f32 v26, 0xbfb8aa3b, v66
    v_exp_f32 v26, v26
    s_nop 0
    v_add_f32 v26, 1.0, v26
    v_rcp_f32 v26, v26
    s_nop 0
    v_mul_f32 v66, v66, v26
    v_cvt_pk_bf16_f32 v66, v66, v66
    v_and_b32 v66, 0xffff0000, v66
    v_mul_f32 v26, 0xbfb8aa3b, v67
    v_exp_f32 v26, v26
    s_nop 0
    v_add_f32 v26, 1.0, v26
    v_rcp_f32 v26, v26
    s_nop 0
    v_mul_f32 v67, v67, v26
    v_cvt_pk_bf16_f32 v67, v67, v67
    v_and_b32 v67, 0xffff0000, v67
    v_mul_f32 v26, 0xbfb8aa3b, v68
    v_exp_f32 v26, v26
    s_nop 0
    v_add_f32 v26, 1.0, v26
    v_rcp_f32 v26, v26
    s_nop 0
    v_mul_f32 v68, v68, v26
    v_cvt_pk_bf16_f32 v68, v68, v68
    v_and_b32 v68, 0xffff0000, v68
    v_mul_f32 v26, 0xbfb8aa3b, v69
    v_exp_f32 v26, v26
    s_nop 0
    v_add_f32 v26, 1.0, v26
    v_rcp_f32 v26, v26
    s_nop 0
    v_mul_f32 v69, v69, v26
    v_cvt_pk_bf16_f32 v69, v69, v69
    v_and_b32 v69, 0xffff0000, v69
    v_mul_f32 v26, 0xbfb8aa3b, v70
    v_exp_f32 v26, v26
    s_nop 0
    v_add_f32 v26, 1.0, v26
    v_rcp_f32 v26, v26
    s_nop 0
    v_mul_f32 v70, v70, v26
    v_cvt_pk_bf16_f32 v70, v70, v70
    v_and_b32 v70, 0xffff0000, v70
    v_mul_f32 v26, 0xbfb8aa3b, v71
    v_exp_f32 v26, v26
    s_nop 0
    v_add_f32 v26, 1.0, v26
    v_rcp_f32 v26, v26
    s_nop 0
    v_mul_f32 v71, v71, v26
    v_cvt_pk_bf16_f32 v71, v71, v71
    v_and_b32 v71, 0xffff0000, v71
L_upp:
    v_bfe_u32 v21, v1, 5, 1
    v_lshlrev_b32 v21, 4, v21
    v_bfe_u32 v21, v22, v21, 16
    v_or_b32 v64, v64, v21
    v_or_b32 v65, v65, v21
    v_or_b32 v66, v66, v21
    v_or_b32 v67, v67, v21
    v_or_b32 v68, v68, v21
    v_or_b32 v69, v69, v21
    v_or_b32 v70, v70, v21
    v_or_b32 v71, v71, v21
    v_lshl_add_u32 v24, v25, 3, v24
    v_lshlrev_b32 v24, 4, v24
    buffer_store_dwordx4 v[64:67], v24, s[48:51], s33 offen sc1
    buffer_store_dwordx4 v[68:71], v24, s[48:51], s33 offen offset:1024 sc1
    s_branch L_fin
L_dnp:
    v_bfe_u32 v21, v1, 0, 1
    v_lshlrev_b32 v21, 4, v21
    v_bfe_u32 v21, v22, v21, 16
    v_bfe_u32 v11, v21, 12, 4
    v_bfe_u32 v10, v21, 8, 4
    v_bfe_u32 v9, v21, 4, 4
    v_bfe_u32 v8, v21, 0, 4
    v_bfi_b32 v64, 15, v8, v64
    v_bfi_b32 v65, 15, v9, v65
    v_bfi_b32 v66, 15, v10, v66
    v_bfi_b32 v67, 15, v11, v67
    v_bfi_b32 v68, 15, v8, v68
    v_bfi_b32 v69, 15, v9, v69
    v_bfi_b32 v70, 15, v10, v70
    v_bfi_b32 v71, 15, v11, v71
    v_mul_u32_u24 v24, 18432, v24
    v_lshl_add_u32 v24, v25, 4, v24
    s_mul_i32 s33, s69, 2304
    s_lshl_b32 s34, s57, 8
    s_add_u32 s33, s33, s34
    s_add_u32 s33, s33, 0x180000
    buffer_store_dwordx4 v[64:67], v24, s[48:51], s33 offen sc1
    buffer_store_dwordx4 v[68:71], v24, s[48:51], s33 offen offset:128 sc1
    s_branch L_fin
L_w0:
    s_mul_i32 s33, s29, 0x24000
    s_mul_i32 s34, s28, 18432
    s_add_u32 s33, s33, s34
    s_add_u32 s44, s12, s33
    s_addc_u32 s45, s13, 0
    s_mov_b32 s46, 0x4800
    s_mov_b32 s47, 0x20000
    v_lshlrev_b32 v71, 7, v1
    s_mov_b32 s34, 0
    buffer_load_dword v70, v71, s[44:47], s34 offen
    s_mov_b32 s34, 8192
    buffer_load_dword v70, v71, s[44:47], s34 offen
    s_mov_b32 s34, 16384
    buffer_load_dword v70, v71, s[44:47], s34 offen
    v_mov_b32 v12, 0
    global_load_dword v13, v12, s[24:25] sc1
    s_memrealtime s[62:63]
    s_waitcnt vmcnt(0) lgkmcnt(0)
    v_readfirstlane_b32 s33, v13
    s_nop 0
    s_cmp_lg_u32 s33, 0
    s_cbranch_scc1 L_nok
    s_or_b32 s34, s62, 1
    v_mov_b32 v14, s34
    v_mov_b32 v15, 0
    s_mov_b64 exec, 1
    global_atomic_cmpswap v13, v12, v[14:15], s[24:25] sc0 sc1
    s_mov_b64 exec, -1
    s_waitcnt vmcnt(0)
    v_readfirstlane_b32 s33, v13
    s_nop 0
    s_cmp_eq_u32 s33, 0
    s_cselect_b32 s33, s34, s33
L_nok:
    v_mov_b32 v15, s33
    ds_write_b32 v12, v15 offset:6224
    s_waitcnt vmcnt(2)
    buffer_load_dwordx4 v[136:139], v68, s[36:39], s54 offen
    s_add_u32 s54, s54, s52
    s_waitcnt vmcnt(2)
    buffer_load_dwordx4 v[140:143], v68, s[36:39], s54 offen
    s_add_u32 s54, s54, s52
    s_waitcnt vmcnt(2)
    buffer_load_dwordx4 v[144:147], v68, s[36:39], s54 offen
    s_add_u32 s54, s54, s52
    s_waitcnt vmcnt(2)
    buffer_load_dwordx4 v[148:151], v68, s[36:39], s54 offen
    s_add_u32 s54, s54, s52
    s_waitcnt vmcnt(2)
    buffer_load_dwordx4 v[152:155], v68, s[36:39], s54 offen
    s_add_u32 s54, s54, s52
    s_waitcnt vmcnt(2)
    buffer_load_dwordx4 v[156:159], v68, s[36:39], s54 offen
    s_add_u32 s54, s54, s52
    s_waitcnt vmcnt(2)
    buffer_load_dwordx4 v[160:163], v68, s[36:39], s54 offen
    s_add_u32 s54, s54, s52
    s_waitcnt vmcnt(2)
    buffer_load_dwordx4 v[164:167], v68, s[36:39], s54 offen
    s_add_u32 s54, s54, s53
    s_waitcnt vmcnt(0)
    s_mov_b32 s60, 0x05040100
    s_mov_b32 s61, 0x07060302
    v_perm_b32 v88, v108, v104, s60
    v_perm_b32 v89, v116, v112, s60
    v_perm_b32 v90, v124, v120, s60
    v_perm_b32 v91, v132, v128, s60
    v_perm_b32 v92, v108, v104, s61
    v_perm_b32 v93, v116, v112, s61
    v_perm_b32 v94, v124, v120, s61
    v_perm_b32 v95, v132, v128, s61
    v_perm_b32 v96, v109, v105, s60
    v_perm_b32 v97, v117, v113, s60
    v_perm_b32 v98, v125, v121, s60
    v_perm_b32 v99, v133, v129, s60
    v_perm_b32 v100, v109, v105, s61
    v_perm_b32 v101, v117, v113, s61
    v_perm_b32 v102, v125, v121, s61
    v_perm_b32 v103, v133, v129, s61
    v_perm_b32 v8, v110, v106, s60
    v_perm_b32 v9, v118, v114, s60
    v_perm_b32 v10, v126, v122, s60
    v_perm_b32 v11, v134, v130, s60
    v_perm_b32 v20, v110, v106, s61
    v_perm_b32 v21, v118, v114, s61
    v_perm_b32 v22, v126, v122, s61
    v_perm_b32 v23, v134, v130, s61
    v_perm_b32 v24, v111, v107, s60
    v_perm_b32 v25, v119, v115, s60
    v_perm_b32 v26, v127, v123, s60
    v_perm_b32 v27, v135, v131, s60
    v_perm_b32 v32, v111, v107, s61
    v_perm_b32 v33, v119, v115, s61
    v_perm_b32 v34, v127, v123, s61
    v_perm_b32 v35, v135, v131, s61
    v_perm_b32 v104, v140, v136, s60
    v_perm_b32 v105, v148, v144, s60
    v_perm_b32 v106, v156, v152, s60
    v_perm_b32 v107, v164, v160, s60
    v_perm_b32 v108, v140, v136, s61
    v_perm_b32 v109, v148, v144, s61
    v_perm_b32 v110, v156, v152, s61
    v_perm_b32 v111, v164, v160, s61
    v_perm_b32 v112, v141, v137, s60
    v_perm_b32 v113, v149, v145, s60
    v_perm_b32 v114, v157, v153, s60
    v_perm_b32 v115, v165, v161, s60
    v_perm_b32 v116, v141, v137, s61
    v_perm_b32 v117, v149, v145, s61
    v_perm_b32 v118, v157, v153, s61
    v_perm_b32 v119, v165, v161, s61
    v_perm_b32 v120, v142, v138, s60
    v_perm_b32 v121, v150, v146, s60
    v_perm_b32 v122, v158, v154, s60
    v_perm_b32 v123, v166, v162, s60
    v_perm_b32 v124, v142, v138, s61
    v_perm_b32 v125, v150, v146, s61
    v_perm_b32 v126, v158, v154, s61
    v_perm_b32 v127, v166, v162, s61
    v_perm_b32 v128, v143, v139, s60
    v_perm_b32 v129, v151, v147, s60
    v_perm_b32 v130, v159, v155, s60
    v_perm_b32 v131, v167, v163, s60
    v_perm_b32 v132, v143, v139, s61
    v_perm_b32 v133, v151, v147, s61
    v_perm_b32 v134, v159, v155, s61
    v_perm_b32 v135, v167, v163, s61
    v_mov_b32 v136, v88
    v_mov_b32 v137, v89
    v_mov_b32 v138, v90
    v_mov_b32 v139, v91
    v_mov_b32 v140, v92
    v_mov_b32 v141, v93
    v_mov_b32 v142, v94
    v_mov_b32 v143, v95
    v_mov_b32 v144, v96
    v_mov_b32 v145, v97
    v_mov_b32 v146, v98
    v_mov_b32 v147, v99
    v_mov_b32 v148, v100
    v_mov_b32 v149, v101
    v_mov_b32 v150, v102
    v_mov_b32 v151, v103
    v_mov_b32 v152, v8
    v_mov_b32 v153, v9
    v_mov_b32 v154, v10
    v_mov_b32 v155, v11
    v_mov_b32 v156, v20
    v_mov_b32 v157, v21
    v_mov_b32 v158, v22
    v_mov_b32 v159, v23
    v_mov_b32 v160, v24
    v_mov_b32 v161, v25
    v_mov_b32 v162, v26
    v_mov_b32 v163, v27
    v_mov_b32 v164, v32
    v_mov_b32 v165, v33
    v_mov_b32 v166, v34
    v_mov_b32 v167, v35
    s_lshl2_add_u32 s33, s28, 3
    s_cmp_lg_u32 s29, s33
    s_cbranch_scc1 L_w0t
    v_mov_b32 v8, 0
L_lwg:
    ds_read_b32 v9, v8 offset:6220
    s_waitcnt lgkmcnt(0)
    v_readfirstlane_b32 s33, v9
    s_nop 0
    s_cmp_ge_u32 s33, 8
    s_cbranch_scc1 L_lgg
    s_sleep 64
    s_branch L_lwg
L_lgg:
    v_bfe_u32 v8, v1, 0, 1
    v_lshlrev_b32 v8, 4, v8
    v_bfe_u32 v8, v15, v8, 16
    v_bfe_u32 v19, v8, 12, 4
    v_bfe_u32 v18, v8, 8, 4
    v_bfe_u32 v17, v8, 4, 4
    v_bfe_u32 v16, v8, 0, 4
    v_lshrrev_b32 v8, 4, v1
    v_and_b32 v9, 15, v1
    v_mul_u32_u24 v8, 2304, v8
    v_lshl_add_u32 v8, v9, 4, v8
    s_mul_i32 s33, s28, 18432
    s_add_u32 s33, s33, 0x180000
    s_add_u32 s34, s33, 9216
    v_lshrrev_b32 v11, 4, v1
    v_bfrev_b32 v11, v11
    v_lshrrev_b32 v11, 30, v11
    v_and_b32 v10, 15, v1
    v_lshl_add_u32 v10, v10, 2, v11
    v_and_b32 v10, 7, v1
    v_lshl_add_u32 v10, v10, 3, v11
    v_bfe_u32 v11, v1, 3, 1
    v_lshl_add_u32 v10, v11, 2, v10
    v_lshlrev_b32 v10, 2, v10
    s_mov_b32 s35, 0
L_gp:
    buffer_load_dwordx4 v[28:31], v8, s[48:51], s33 offen offset:0 sc1
    buffer_load_dwordx4 v[32:35], v8, s[48:51], s34 offen offset:0 sc1
    buffer_load_dwordx4 v[36:39], v8, s[48:51], s33 offen offset:256 sc1
    buffer_load_dwordx4 v[40:43], v8, s[48:51], s34 offen offset:256 sc1
    buffer_load_dwordx4 v[44:47], v8, s[48:51], s33 offen offset:512 sc1
    buffer_load_dwordx4 v[48:51], v8, s[48:51], s34 offen offset:512 sc1
    buffer_load_dwordx4 v[52:55], v8, s[48:51], s33 offen offset:768 sc1
    buffer_load_dwordx4 v[56:59], v8, s[48:51], s34 offen offset:768 sc1
    buffer_load_dwordx4 v[60:63], v8, s[48:51], s33 offen offset:1024 sc1
    buffer_load_dwordx4 v[64:67], v8, s[48:51], s34 offen offset:1024 sc1
    buffer_load_dwordx4 v[68:71], v8, s[48:51], s33 offen offset:1280 sc1
    buffer_load_dwordx4 v[72:75], v8, s[48:51], s34 offen offset:1280 sc1
    buffer_load_dwordx4 v[76:79], v8, s[48:51], s33 offen offset:1536 sc1
    buffer_load_dwordx4 v[80:83], v8, s[48:51], s34 offen offset:1536 sc1
    buffer_load_dwordx4 v[84:87], v8, s[48:51], s33 offen offset:1792 sc1
    buffer_load_dwordx4 v[88:91], v8, s[48:51], s34 offen offset:1792 sc1
    buffer_load_dwordx4 v[92:95], v8, s[48:51], s33 offen offset:2048 sc1
    buffer_load_dwordx4 v[96:99], v8, s[48:51], s34 offen offset:2048 sc1
    s_waitcnt vmcnt(0)
    v_mov_b32 v24, 0
    v_bitop3_b32 v25, v28, v32, v16 bitop3:0x7e
    v_bitop3_b32 v26, v29, v33, v17 bitop3:0x7e
    v_or3_b32 v24, v24, v25, v26
    v_bitop3_b32 v25, v30, v34, v18 bitop3:0x7e
    v_bitop3_b32 v26, v31, v35, v19 bitop3:0x7e
    v_or3_b32 v24, v24, v25, v26
    v_bitop3_b32 v25, v36, v40, v16 bitop3:0x7e
    v_bitop3_b32 v26, v37, v41, v17 bitop3:0x7e
    v_or3_b32 v24, v24, v25, v26
    v_bitop3_b32 v25, v38, v42, v18 bitop3:0x7e
    v_bitop3_b32 v26, v39, v43, v19 bitop3:0x7e
    v_or3_b32 v24, v24, v25, v26
    v_bitop3_b32 v25, v44, v48, v16 bitop3:0x7e
    v_bitop3_b32 v26, v45, v49, v17 bitop3:0x7e
    v_or3_b32 v24, v24, v25, v26
    v_bitop3_b32 v25, v46, v50, v18 bitop3:0x7e
    v_bitop3_b32 v26, v47, v51, v19 bitop3:0x7e
    v_or3_b32 v24, v24, v25, v26
    v_bitop3_b32 v25, v52, v56, v16 bitop3:0x7e
    v_bitop3_b32 v26, v53, v57, v17 bitop3:0x7e
    v_or3_b32 v24, v24, v25, v26
    v_bitop3_b32 v25, v54, v58, v18 bitop3:0x7e
    v_bitop3_b32 v26, v55, v59, v19 bitop3:0x7e
    v_or3_b32 v24, v24, v25, v26
    v_bitop3_b32 v25, v60, v64, v16 bitop3:0x7e
    v_bitop3_b32 v26, v61, v65, v17 bitop3:0x7e
    v_or3_b32 v24, v24, v25, v26
    v_bitop3_b32 v25, v62, v66, v18 bitop3:0x7e
    v_bitop3_b32 v26, v63, v67, v19 bitop3:0x7e
    v_or3_b32 v24, v24, v25, v26
    v_bitop3_b32 v25, v68, v72, v16 bitop3:0x7e
    v_bitop3_b32 v26, v69, v73, v17 bitop3:0x7e
    v_or3_b32 v24, v24, v25, v26
    v_bitop3_b32 v25, v70, v74, v18 bitop3:0x7e
    v_bitop3_b32 v26, v71, v75, v19 bitop3:0x7e
    v_or3_b32 v24, v24, v25, v26
    v_bitop3_b32 v25, v76, v80, v16 bitop3:0x7e
    v_bitop3_b32 v26, v77, v81, v17 bitop3:0x7e
    v_or3_b32 v24, v24, v25, v26
    v_bitop3_b32 v25, v78, v82, v18 bitop3:0x7e
    v_bitop3_b32 v26, v79, v83, v19 bitop3:0x7e
    v_or3_b32 v24, v24, v25, v26
    v_bitop3_b32 v25, v84, v88, v16 bitop3:0x7e
    v_bitop3_b32 v26, v85, v89, v17 bitop3:0x7e
    v_or3_b32 v24, v24, v25, v26
    v_bitop3_b32 v25, v86, v90, v18 bitop3:0x7e
    v_bitop3_b32 v26, v87, v91, v19 bitop3:0x7e
    v_or3_b32 v24, v24, v25, v26
    v_bitop3_b32 v25, v92, v96, v16 bitop3:0x7e
    v_bitop3_b32 v26, v93, v97, v17 bitop3:0x7e
    v_or3_b32 v24, v24, v25, v26
    v_bitop3_b32 v25, v94, v98, v18 bitop3:0x7e
    v_bitop3_b32 v26, v95, v99, v19 bitop3:0x7e
    v_or3_b32 v24, v24, v25, v26
    v_and_b32 v24, 15, v24
    v_cmp_ne_u32 vcc, 0, v24
    s_cbranch_vccz L_gok
    s_add_u32 s35, s35, 1
    s_cmp_gt_u32 s35, 0x40000
    s_cbranch_scc1 L_fin
    s_sleep 64
    s_branch L_gp
L_gok:
    v_and_b32 v28, -16, v28
    v_and_b32 v29, -16, v29
    v_and_b32 v30, -16, v30
    v_and_b32 v31, -16, v31
    v_and_b32 v32, -16, v32
    v_and_b32 v33, -16, v33
    v_and_b32 v34, -16, v34
    v_and_b32 v35, -16, v35
    v_pk_add_f32 v[28:29], v[28:29], v[32:33]
    v_pk_add_f32 v[30:31], v[30:31], v[34:35]
    s_nop 0
    v_permlane32_swap_b32 v28, v29
    v_permlane32_swap_b32 v30, v31
    v_add_f32 v28, v28, v29
    v_add_f32 v30, v30, v31
    s_nop 1
    v_permlane16_swap_b32 v28, v30
    v_add_f32 v28, v28, v30
    v_cvt_pk_bf16_f32 v28, v28, v28
    v_and_b32 v28, 0xffff0000, v28
    v_mul_f32 v30, 0xbfb8aa3b, v28
    v_exp_f32 v30, v30
    s_nop 0
    v_add_f32 v30, 1.0, v30
    v_rcp_f32 v30, v30
    s_nop 0
    v_mul_f32 v29, v28, v30
    v_cvt_pk_bf16_f32 v29, v29, v29
    v_and_b32 v29, 0xffff0000, v29
    ds_write_b32 v10, v29 offset:6272
    v_and_b32 v36, -16, v36
    v_and_b32 v37, -16, v37
    v_and_b32 v38, -16, v38
    v_and_b32 v39, -16, v39
    v_and_b32 v40, -16, v40
    v_and_b32 v41, -16, v41
    v_and_b32 v42, -16, v42
    v_and_b32 v43, -16, v43
    v_pk_add_f32 v[36:37], v[36:37], v[40:41]
    v_pk_add_f32 v[38:39], v[38:39], v[42:43]
    s_nop 0
    v_permlane32_swap_b32 v36, v37
    v_permlane32_swap_b32 v38, v39
    v_add_f32 v36, v36, v37
    v_add_f32 v38, v38, v39
    s_nop 1
    v_permlane16_swap_b32 v36, v38
    v_add_f32 v36, v36, v38
    v_cvt_pk_bf16_f32 v36, v36, v36
    v_and_b32 v36, 0xffff0000, v36
    v_mul_f32 v38, 0xbfb8aa3b, v36
    v_exp_f32 v38, v38
    s_nop 0
    v_add_f32 v38, 1.0, v38
    v_rcp_f32 v38, v38
    s_nop 0
    v_mul_f32 v37, v36, v38
    v_cvt_pk_bf16_f32 v37, v37, v37
    v_and_b32 v37, 0xffff0000, v37
    ds_write_b32 v10, v37 offset:6528
    v_and_b32 v44, -16, v44
    v_and_b32 v45, -16, v45
    v_and_b32 v46, -16, v46
    v_and_b32 v47, -16, v47
    v_and_b32 v48, -16, v48
    v_and_b32 v49, -16, v49
    v_and_b32 v50, -16, v50
    v_and_b32 v51, -16, v51
    v_pk_add_f32 v[44:45], v[44:45], v[48:49]
    v_pk_add_f32 v[46:47], v[46:47], v[50:51]
    s_nop 0
    v_permlane32_swap_b32 v44, v45
    v_permlane32_swap_b32 v46, v47
    v_add_f32 v44, v44, v45
    v_add_f32 v46, v46, v47
    s_nop 1
    v_permlane16_swap_b32 v44, v46
    v_add_f32 v44, v44, v46
    v_cvt_pk_bf16_f32 v44, v44, v44
    v_and_b32 v44, 0xffff0000, v44
    v_mul_f32 v46, 0xbfb8aa3b, v44
    v_exp_f32 v46, v46
    s_nop 0
    v_add_f32 v46, 1.0, v46
    v_rcp_f32 v46, v46
    s_nop 0
    v_mul_f32 v45, v44, v46
    v_cvt_pk_bf16_f32 v45, v45, v45
    v_and_b32 v45, 0xffff0000, v45
    ds_write_b32 v10, v45 offset:6784
    v_and_b32 v52, -16, v52
    v_and_b32 v53, -16, v53
    v_and_b32 v54, -16, v54
    v_and_b32 v55, -16, v55
    v_and_b32 v56, -16, v56
    v_and_b32 v57, -16, v57
    v_and_b32 v58, -16, v58
    v_and_b32 v59, -16, v59
    v_pk_add_f32 v[52:53], v[52:53], v[56:57]
    v_pk_add_f32 v[54:55], v[54:55], v[58:59]
    s_nop 0
    v_permlane32_swap_b32 v52, v53
    v_permlane32_swap_b32 v54, v55
    v_add_f32 v52, v52, v53
    v_add_f32 v54, v54, v55
    s_nop 1
    v_permlane16_swap_b32 v52, v54
    v_add_f32 v52, v52, v54
    v_cvt_pk_bf16_f32 v52, v52, v52
    v_and_b32 v52, 0xffff0000, v52
    v_mul_f32 v54, 0xbfb8aa3b, v52
    v_exp_f32 v54, v54
    s_nop 0
    v_add_f32 v54, 1.0, v54
    v_rcp_f32 v54, v54
    s_nop 0
    v_mul_f32 v53, v52, v54
    v_cvt_pk_bf16_f32 v53, v53, v53
    v_and_b32 v53, 0xffff0000, v53
    ds_write_b32 v10, v53 offset:7040
    v_and_b32 v60, -16, v60
    v_and_b32 v61, -16, v61
    v_and_b32 v62, -16, v62
    v_and_b32 v63, -16, v63
    v_and_b32 v64, -16, v64
    v_and_b32 v65, -16, v65
    v_and_b32 v66, -16, v66
    v_and_b32 v67, -16, v67
    v_pk_add_f32 v[60:61], v[60:61], v[64:65]
    v_pk_add_f32 v[62:63], v[62:63], v[66:67]
    s_nop 0
    v_permlane32_swap_b32 v60, v61
    v_permlane32_swap_b32 v62, v63
    v_add_f32 v60, v60, v61
    v_add_f32 v62, v62, v63
    s_nop 1
    v_permlane16_swap_b32 v60, v62
    v_add_f32 v60, v60, v62
    v_cvt_pk_bf16_f32 v60, v60, v60
    v_and_b32 v60, 0xffff0000, v60
    v_mul_f32 v62, 0xbfb8aa3b, v60
    v_exp_f32 v62, v62
    s_nop 0
    v_add_f32 v62, 1.0, v62
    v_rcp_f32 v62, v62
    s_nop 0
    v_mul_f32 v61, v60, v62
    v_cvt_pk_bf16_f32 v61, v61, v61
    v_and_b32 v61, 0xffff0000, v61
    ds_write_b32 v10, v61 offset:7296
    v_and_b32 v68, -16, v68
    v_and_b32 v69, -16, v69
    v_and_b32 v70, -16, v70
    v_and_b32 v71, -16, v71
    v_and_b32 v72, -16, v72
    v_and_b32 v73, -16, v73
    v_and_b32 v74, -16, v74
    v_and_b32 v75, -16, v75
    v_pk_add_f32 v[68:69], v[68:69], v[72:73]
    v_pk_add_f32 v[70:71], v[70:71], v[74:75]
    s_nop 0
    v_permlane32_swap_b32 v68, v69
    v_permlane32_swap_b32 v70, v71
    v_add_f32 v68, v68, v69
    v_add_f32 v70, v70, v71
    s_nop 1
    v_permlane16_swap_b32 v68, v70
    v_add_f32 v68, v68, v70
    v_cvt_pk_bf16_f32 v68, v68, v68
    v_and_b32 v68, 0xffff0000, v68
    v_mul_f32 v70, 0xbfb8aa3b, v68
    v_exp_f32 v70, v70
    s_nop 0
    v_add_f32 v70, 1.0, v70
    v_rcp_f32 v70, v70
    s_nop 0
    v_mul_f32 v69, v68, v70
    v_cvt_pk_bf16_f32 v69, v69, v69
    v_and_b32 v69, 0xffff0000, v69
    ds_write_b32 v10, v69 offset:7552
    v_and_b32 v76, -16, v76
    v_and_b32 v77, -16, v77
    v_and_b32 v78, -16, v78
    v_and_b32 v79, -16, v79
    v_and_b32 v80, -16, v80
    v_and_b32 v81, -16, v81
    v_and_b32 v82, -16, v82
    v_and_b32 v83, -16, v83
    v_pk_add_f32 v[76:77], v[76:77], v[80:81]
    v_pk_add_f32 v[78:79], v[78:79], v[82:83]
    s_nop 0
    v_permlane32_swap_b32 v76, v77
    v_permlane32_swap_b32 v78, v79
    v_add_f32 v76, v76, v77
    v_add_f32 v78, v78, v79
    s_nop 1
    v_permlane16_swap_b32 v76, v78
    v_add_f32 v76, v76, v78
    v_cvt_pk_bf16_f32 v76, v76, v76
    v_and_b32 v76, 0xffff0000, v76
    v_mul_f32 v78, 0xbfb8aa3b, v76
    v_exp_f32 v78, v78
    s_nop 0
    v_add_f32 v78, 1.0, v78
    v_rcp_f32 v78, v78
    s_nop 0
    v_mul_f32 v77, v76, v78
    v_cvt_pk_bf16_f32 v77, v77, v77
    v_and_b32 v77, 0xffff0000, v77
    ds_write_b32 v10, v77 offset:7808
    v_and_b32 v84, -16, v84
    v_and_b32 v85, -16, v85
    v_and_b32 v86, -16, v86
    v_and_b32 v87, -16, v87
    v_and_b32 v88, -16, v88
    v_and_b32 v89, -16, v89
    v_and_b32 v90, -16, v90
    v_and_b32 v91, -16, v91
    v_pk_add_f32 v[84:85], v[84:85], v[88:89]
    v_pk_add_f32 v[86:87], v[86:87], v[90:91]
    s_nop 0
    v_permlane32_swap_b32 v84, v85
    v_permlane32_swap_b32 v86, v87
    v_add_f32 v84, v84, v85
    v_add_f32 v86, v86, v87
    s_nop 1
    v_permlane16_swap_b32 v84, v86
    v_add_f32 v84, v84, v86
    v_cvt_pk_bf16_f32 v84, v84, v84
    v_and_b32 v84, 0xffff0000, v84
    v_mul_f32 v86, 0xbfb8aa3b, v84
    v_exp_f32 v86, v86
    s_nop 0
    v_add_f32 v86, 1.0, v86
    v_rcp_f32 v86, v86
    s_nop 0
    v_mul_f32 v85, v84, v86
    v_cvt_pk_bf16_f32 v85, v85, v85
    v_and_b32 v85, 0xffff0000, v85
    ds_write_b32 v10, v85 offset:8064
    v_and_b32 v92, -16, v92
    v_and_b32 v93, -16, v93
    v_and_b32 v94, -16, v94
    v_and_b32 v95, -16, v95
    v_and_b32 v96, -16, v96
    v_and_b32 v97, -16, v97
    v_and_b32 v98, -16, v98
    v_and_b32 v99, -16, v99
    v_pk_add_f32 v[92:93], v[92:93], v[96:97]
    v_pk_add_f32 v[94:95], v[94:95], v[98:99]
    s_nop 0
    v_permlane32_swap_b32 v92, v93
    v_permlane32_swap_b32 v94, v95
    v_add_f32 v92, v92, v93
    v_add_f32 v94, v94, v95
    s_nop 1
    v_permlane16_swap_b32 v92, v94
    v_add_f32 v92, v92, v94
    v_cvt_pk_bf16_f32 v92, v92, v92
    v_and_b32 v92, 0xffff0000, v92
    v_mul_f32 v94, 0xbfb8aa3b, v92
    v_exp_f32 v94, v94
    s_nop 0
    v_add_f32 v94, 1.0, v94
    v_rcp_f32 v94, v94
    s_nop 0
    v_mul_f32 v93, v92, v94
    v_cvt_pk_bf16_f32 v93, v93, v93
    v_and_b32 v93, 0xffff0000, v93
    ds_write_b32 v10, v93 offset:8320
L_w0t:
    v_mov_b32 v38, 0
L_lwtw:
    ds_read_b32 v39, v38 offset:6224
    s_waitcnt lgkmcnt(0)
    v_readfirstlane_b32 s33, v39
    s_nop 0
    s_cmp_ge_u32 s33, 1
    s_cbranch_scc1 L_lgtw
    s_sleep 4
    s_branch L_lwtw
L_lgtw:
    v_bfe_u32 v0, v1, 4, 1
    v_lshlrev_b32 v0, 4, v0
    v_bfe_u32 v0, v39, v0, 16
    v_lshlrev_b32 v38, 3, v1
    v_and_b32 v3, 7, v1
    v_lshrrev_b32 v39, 4, v1
    v_lshlrev_b32 v3, 5, v3
    v_lshl_add_u32 v3, v39, 4, v3
    v_lshrrev_b32 v39, 3, v1
    v_lshlrev_b32 v39, 4, v39
    s_mul_i32 s16, s65, 2304
    s_lshl_b32 s66, s67, 8
    s_add_u32 s16, s16, s66
    s_mov_b32 s56, 0xffff0000
    s_mov_b32 s57, 0xffff0000
    s_setprio 3
    s_branch L_tail
L_end:
    s_endpgm
.section .rodata,"a"
.p2align 6
.amdhsa_kernel recurrent_scan__mha_block_cached__glu_gated_swiglu__decode_kernel
  .amdhsa_next_free_vgpr 168
  .amdhsa_next_free_sgpr 100
  .amdhsa_accum_offset 168
  .amdhsa_group_segment_fixed_size 0
  .amdhsa_kernarg_size 96
  .amdhsa_user_sgpr_count 2
  .amdhsa_user_sgpr_kernarg_segment_ptr 1
  .amdhsa_system_sgpr_workgroup_id_x 1
.end_amdhsa_kernel
```
